```python
import torch

def _softmax(x, axis=-1):
    return torch.softmax(x, dim=axis)
def _gelu(x):
    return torch.nn.functional.gelu(x, approximate="tanh")
def _silu(x):
    return torch.nn.functional.silu(x)
def _sigmoid(x):
    return torch.sigmoid(x)
def _layernorm(x, axis=-1, eps=1e-5):
    m = x.mean(dim=axis, keepdim=True)
    v = x.var(dim=axis, keepdim=True, unbiased=False)
    return (x - m) / torch.sqrt(v + eps)
def _scatter_add(tgt, idx, src, axis=0):
    return tgt.clone().index_add_(axis, idx, src)
def _segment_sum(src, seg, n):
    out = torch.zeros((n,) + src.shape[1:], dtype=src.dtype)
    return out.index_add_(0, seg, src)
def _pad(x, pw):
    flat = tuple(v for pair in reversed(pw) for v in pair)
    return torch.nn.functional.pad(x, flat)

kernel_name = 'concat_heads__linear_attn_block__ssm_conv_s4d__prompt'

def setup_inputs():

    _w = (lambda a: (lambda t: t.to(torch.bfloat16) if t.is_floating_point() else t)(torch.as_tensor(a)))
    def _A_setup():
        B, S, D = 1, 2048, 1024
        return {
            "x": _w((lambda *s: torch.randn(*s, dtype=torch.bfloat16) * 0.05)(B, S, D)),
            "wqkv": _w((lambda *s: torch.randn(*s, dtype=torch.bfloat16) * 0.8)(D, 3 * D)),
            "wo": _w((lambda *s: torch.randn(*s, dtype=torch.bfloat16) * 0.05)(D, D)),
        }
    _A_in = _A_setup()

    def _B_setup():
        Bsz, L, D, N = 1, 2048, 1024, 128
        return {
            "u": _w((lambda *s: torch.randn(*s, dtype=torch.bfloat16) * 0.05)(Bsz, L, D)),
            "log_A_real": _w((lambda *s: torch.randn(*s, dtype=torch.bfloat16) * 3.2)(D, N) * 0.5),
            "A_imag": _w((lambda *s: torch.randn(*s, dtype=torch.bfloat16) * 0.05)(D, N) * 3.14),
            "C_real": _w((lambda *s: torch.randn(*s, dtype=torch.bfloat16) * 0.8)(D, N) / N ** 0.5),
            "C_imag": _w((lambda *s: torch.randn(*s, dtype=torch.bfloat16) * 0.8)(D, N) / N ** 0.5),
            "log_dt": _w((lambda *s: torch.randn(*s, dtype=torch.bfloat16) * 0.05)(D) * 0.5 - 4.0),
            "D_skip": _w((lambda *s: torch.randn(*s, dtype=torch.bfloat16) * 0.1)(D)),
        }
    _B_in = _B_setup()

    return {
        "A_x": _A_in["x"],
        "A_wqkv": _A_in["wqkv"],
        "A_wo": _A_in["wo"],
        "B_u": _B_in["u"],
        "B_log_A_real": _B_in["log_A_real"],
        "B_A_imag": _B_in["A_imag"],
        "B_C_real": _B_in["C_real"],
        "B_C_imag": _B_in["C_imag"],
        "B_log_dt": _B_in["log_dt"],
        "B_D_skip": _B_in["D_skip"],
    }

def reference(A_x, A_wqkv, A_wo, B_u, B_log_A_real, B_A_imag, B_C_real, B_C_imag, B_log_dt, B_D_skip):
    def _A_ref(x, wqkv, wo):
        B, S, D = x.shape
        H = 32; Dh = D // H
        qkv = (lambda x, *d: x.permute(*d))((x @ wqkv).reshape(B, S, 3, H, Dh), 2, 0, 3, 1, 4)
        q, k, v = qkv[0], qkv[1], qkv[2]
        phi = lambda t: torch.where(t > 0, t + 1, torch.exp(t)) + 1e-6
        pq, pk = phi(q), phi(k)
        kv = torch.einsum("bhsd,bhse->bhde", pk, v)
        z = torch.einsum("bhsd->bhd", pk)
        num = torch.einsum("bhqd,bhde->bhqe", pq, kv)
        den = torch.einsum("bhqd,bhd->bhq", pq, z)[..., None] + 1e-6
        o = num / den
        return (lambda x, *d: x.permute(*d))(o, 0, 2, 1, 3).reshape(B, S, D) @ wo

    def _B_ref(u, log_A_real, A_imag, C_real, C_imag, log_dt, D_skip):
        L = u.shape[1]
        dt = torch.exp(log_dt)
        A = -torch.exp(log_A_real) + 1j * A_imag
        C = (C_real + 1j * C_imag) * dt[:, None]
        pos = (lambda x, dt: x.to(dt))(torch.arange(L), log_dt.dtype)
        P = torch.exp((A * dt[:, None])[:, :, None] * pos[None, None, :])
        K = 2.0 * torch.einsum("dn,dnl->dl", C, P).real
        L2 = 2 * L
        u_t = (lambda x, *d: x.permute(*d))(u, 0, 2, 1)
        Kf = (lambda x, *a, **k: torch.fft.rfft(x.float(), *a, **k))(K, L2)
        Uf = (lambda x, *a, **k: torch.fft.rfft(x.float(), *a, **k))(u_t, L2)
        y = (lambda x, *a, **k: torch.fft.irfft(x, *a, **k).to(torch.bfloat16))(Uf * Kf[None, :, :], L2)[:, :, :L]
        y = (lambda x, *d: x.permute(*d))(y, 0, 2, 1)
        return y + u * D_skip[None, None, :]

    a = _A_ref(A_x, A_wqkv, A_wo)
    b = _B_ref(B_u, B_log_A_real, B_A_imag, B_C_real, B_C_imag, B_log_dt, B_D_skip)
    return torch.concatenate([a, b], axis=-1)
```

```asm
; @launch kernel=k1_kernel grid=(512,1,1) block=(256,1,1) lds=81920
; @launch kernel=k2_kernel grid=(256,1,1) block=(256,1,1) lds=157440
.amdgcn_target "amdgcn-amd-amdhsa--gfx950"

.text
.globl k1_kernel
.p2align 8
.type k1_kernel,@function
k1_kernel:
    s_cmp_ge_u32 s2, 512
    s_cbranch_scc1 L_k1_end
    s_xor_b32 s2, s2, 0
    s_load_dwordx8 s[32:39], s[0:1], 0
    s_load_dwordx8 s[48:55], s[0:1], 32
    s_load_dwordx2 s[56:57], s[0:1], 64
    s_load_dwordx2 s[58:59], s[0:1], 96
    v_and_b32 v1, 63, v0
    v_lshrrev_b32 v2, 6, v0
    s_nop 0
    v_readfirstlane_b32 s22, v2
    s_waitcnt lgkmcnt(0)
    s_mov_b32 s12, s58
    s_mov_b32 s13, s59
    s_mov_b32 s14, 0x10000000
    s_mov_b32 s15, 0x00020000
    s_cmp_ge_u32 s2, 256
    s_cbranch_scc1 L_k1_aux
    s_setprio 0
    s_and_b32 s16, s2, 7
    s_lshr_b32 s17, s2, 3
    s_and_b32 s18, s16, 1
    s_lshl_b32 s18, s18, 3
    s_and_b32 s19, s17, 7
    s_add_u32 s18, s18, s19
    s_lshr_b32 s19, s16, 1
    s_lshl_b32 s19, s19, 2
    s_lshr_b32 s20, s17, 3
    s_add_u32 s19, s19, s20
    s_mov_b32 s4, s32
    s_mov_b32 s5, s33
    s_mov_b32 s6, 0x400000
    s_mov_b32 s7, 0x00020000
    s_mov_b32 s8, s34
    s_mov_b32 s9, s35
    s_mov_b32 s10, 0x600000
    s_mov_b32 s11, 0x00020000
    s_and_b32 s20, s22, 1
    s_cmp_eq_u32 s20, 0
    s_cselect_b32 s84, s32, s34
    s_cselect_b32 s85, s33, s35
    s_cselect_b32 s86, 0x400000, s10
    s_mov_b32 s87, 0x00020000
    s_mov_b32 s21, 786432
    s_cselect_b32 s89, 256, s21
    s_and_b32 s20, s16, 1
    s_lshl_b32 s20, s20, 10
    s_lshl_b32 s21, s17, 5
    s_add_u32 s20, s20, s21
    v_and_b32 v9, 31, v1
    v_add_u32 v9, s20, v9
    v_lshlrev_b32 v9, 11, v9
    v_lshrrev_b32 v10, 5, v1
    v_lshlrev_b32 v10, 7, v10
    v_add_u32 v9, v9, v10
    s_lshl_b32 s20, s17, 2
    v_lshrrev_b32 v10, 4, v1
    v_add_u32 v10, s20, v10
    v_mul_u32_u24 v10, 6144, v10
    v_and_b32 v11, 15, v1
    v_min_u32 v11, 11, v11
    v_lshrrev_b32 v12, 2, v11
    v_lshlrev_b32 v12, 11, v12
    v_and_b32 v11, 3, v11
    v_lshlrev_b32 v11, 7, v11
    v_add3_u32 v10, v10, v11, v12
    s_lshr_b32 s20, s16, 1
    s_lshl_b32 s20, s20, 9
    v_add_u32 v10, s20, v10
    s_and_b32 s20, s22, 1
    v_cmp_eq_u32 vcc, 0, s20
    s_nop 1
    v_cndmask_b32 v219, v10, v9, vcc
    s_mov_b32 s88, 0
    s_lshl_b32 s20, s18, 7
    s_lshl_b32 s21, s22, 5
    s_add_u32 s20, s20, s21
    v_lshrrev_b32 v2, 3, v1
    v_add_u32 v2, s20, v2
    v_lshlrev_b32 v2, 11, v2
    v_and_b32 v3, 7, v1
    v_lshrrev_b32 v4, 4, v1
    v_xor_b32 v3, v3, v4
    v_lshlrev_b32 v3, 4, v3
    v_add_u32 v216, v2, v3
    v_xor_b32 v3, 64, v3
    v_add_u32 v217, v2, v3
    v_add_u32 v217, 16384, v217
    s_lshl_b32 s20, s22, 3
    v_lshrrev_b32 v3, 3, v1
    v_add_u32 v3, s20, v3
    v_mul_u32_u24 v3, 6144, v3
    s_lshl_b32 s20, s19, 7
    v_add_u32 v3, s20, v3
    v_and_b32 v4, 7, v1
    v_lshrrev_b32 v5, 4, v1
    v_and_b32 v5, 1, v5
    v_lshlrev_b32 v5, 2, v5
    v_xor_b32 v4, v4, v5
    v_lshlrev_b32 v4, 4, v4
    v_add_u32 v218, v3, v4
    s_lshl_b32 s62, s22, 12
    s_lshl_b32 s63, s22, 10
    s_add_u32 s63, s63, 32768
    s_mov_b32 s27, 0
    s_mov_b32 s28, 0
    s_add_u32 m0, s62, 0
    s_add_u32 s31, s27, 32768
    buffer_load_dwordx4 v216, s[4:7], s27 offen lds
    s_add_u32 m0, s62, 1024
    s_nop 0
    buffer_load_dwordx4 v217, s[4:7], s27 offen lds
    s_add_u32 m0, s62, 2048
    s_nop 0
    buffer_load_dwordx4 v216, s[4:7], s31 offen lds
    s_add_u32 m0, s62, 3072
    s_add_u32 s27, s27, 128
    buffer_load_dwordx4 v217, s[4:7], s31 offen lds
    s_cmp_lt_u32 s27, 2048
    s_cselect_b32 s27, s27, 0x10000000
    s_add_u32 m0, s63, 0
    s_add_u32 s30, s28, 2048
    buffer_load_dwordx4 v218, s[8:11], s28 offen lds
    s_add_u32 m0, s63, 4096
    s_add_u32 s31, s28, 4096
    buffer_load_dwordx4 v218, s[8:11], s30 offen lds
    s_add_u32 m0, s63, 8192
    s_add_u32 s28, s28, 196608
    buffer_load_dwordx4 v218, s[8:11], s31 offen lds
    buffer_load_dword v220, v219, s[84:87], s88 offen
    s_add_u32 s88, s88, s89
    buffer_load_dword v220, v219, s[84:87], s88 offen
    s_add_u32 s88, s88, s89
    buffer_load_dword v220, v219, s[84:87], s88 offen
    s_add_u32 s88, s88, s89
    s_add_u32 m0, s63, 12288
    s_add_u32 s30, s28, 2048
    buffer_load_dwordx4 v218, s[8:11], s28 offen lds
    s_add_u32 m0, s63, 16384
    s_add_u32 s31, s28, 4096
    buffer_load_dwordx4 v218, s[8:11], s30 offen lds
    s_add_u32 m0, s63, 20480
    s_add_u32 s28, s28, 196608
    buffer_load_dwordx4 v218, s[8:11], s31 offen lds
    s_add_u32 m0, s63, 24576
    s_add_u32 s30, s28, 2048
    buffer_load_dwordx4 v218, s[8:11], s28 offen lds
    s_add_u32 m0, s63, 28672
    s_add_u32 s31, s28, 4096
    buffer_load_dwordx4 v218, s[8:11], s30 offen lds
    s_add_u32 m0, s63, 32768
    s_add_u32 s28, s28, 196608
    buffer_load_dwordx4 v218, s[8:11], s31 offen lds
    s_add_u32 m0, s62, 16384
    s_add_u32 s31, s27, 32768
    buffer_load_dwordx4 v216, s[4:7], s27 offen lds
    s_add_u32 m0, s62, 17408
    s_nop 0
    buffer_load_dwordx4 v217, s[4:7], s27 offen lds
    s_add_u32 m0, s62, 18432
    s_nop 0
    buffer_load_dwordx4 v216, s[4:7], s31 offen lds
    s_add_u32 m0, s62, 19456
    s_add_u32 s27, s27, 128
    buffer_load_dwordx4 v217, s[4:7], s31 offen lds
    s_cmp_lt_u32 s27, 2048
    s_cselect_b32 s27, s27, 0x10000000
    s_and_b32 s23, s22, 1
    s_lshr_b32 s24, s22, 1
    v_and_b32 v10, 31, v1
    v_lshrrev_b32 v11, 5, v1
    s_lshl_b32 s20, s23, 6
    v_add_u32 v12, s20, v10
    v_lshlrev_b32 v12, 7, v12
    v_lshrrev_b32 v13, 1, v10
    v_and_b32 v13, 7, v13
    v_xor_b32 v14, v11, v13
    v_lshlrev_b32 v14, 4, v14
    v_add_u32 v4, v12, v14
    v_xor_b32 v5, 32, v4
    v_xor_b32 v6, 64, v4
    v_xor_b32 v7, 96, v4
    v_lshrrev_b32 v10, 5, v1
    v_lshlrev_b32 v10, 3, v10
    v_and_b32 v11, 15, v1
    v_lshrrev_b32 v11, 2, v11
    v_add_u32 v10, v10, v11
    v_lshlrev_b32 v10, 7, v10
    v_lshrrev_b32 v12, 4, v1
    v_and_b32 v12, 1, v12
    v_lshlrev_b32 v12, 1, v12
    v_and_b32 v13, 3, v1
    v_lshrrev_b32 v14, 1, v13
    v_add_u32 v12, v12, v14
    s_lshl_b32 s20, s24, 2
    v_add_u32 v12, s20, v12
    v_lshrrev_b32 v11, 1, v11
    v_and_b32 v11, 1, v11
    v_lshlrev_b32 v11, 2, v11
    v_xor_b32 v12, v12, v11
    v_lshlrev_b32 v12, 4, v12
    v_add_u32 v10, v10, v12
    v_and_b32 v13, 1, v13
    v_lshlrev_b32 v13, 3, v13
    v_add_u32 v10, v10, v13
    v_add_u32 v8, 32768, v10
    v_mov_b32 v16, 0
    v_mov_b32 v17, 0
    v_mov_b32 v18, 0
    v_mov_b32 v19, 0
    v_mov_b32 v20, 0
    v_mov_b32 v21, 0
    v_mov_b32 v22, 0
    v_mov_b32 v23, 0
    v_mov_b32 v24, 0
    v_mov_b32 v25, 0
    v_mov_b32 v26, 0
    v_mov_b32 v27, 0
    v_mov_b32 v28, 0
    v_mov_b32 v29, 0
    v_mov_b32 v30, 0
    v_mov_b32 v31, 0
    v_mov_b32 v32, 0
    v_mov_b32 v33, 0
    v_mov_b32 v34, 0
    v_mov_b32 v35, 0
    v_mov_b32 v36, 0
    v_mov_b32 v37, 0
    v_mov_b32 v38, 0
    v_mov_b32 v39, 0
    v_mov_b32 v40, 0
    v_mov_b32 v41, 0
    v_mov_b32 v42, 0
    v_mov_b32 v43, 0
    v_mov_b32 v44, 0
    v_mov_b32 v45, 0
    v_mov_b32 v46, 0
    v_mov_b32 v47, 0
    v_mov_b32 v48, 0
    v_mov_b32 v49, 0
    v_mov_b32 v50, 0
    v_mov_b32 v51, 0
    v_mov_b32 v52, 0
    v_mov_b32 v53, 0
    v_mov_b32 v54, 0
    v_mov_b32 v55, 0
    v_mov_b32 v56, 0
    v_mov_b32 v57, 0
    v_mov_b32 v58, 0
    v_mov_b32 v59, 0
    v_mov_b32 v60, 0
    v_mov_b32 v61, 0
    v_mov_b32 v62, 0
    v_mov_b32 v63, 0
    v_mov_b32 v64, 0
    v_mov_b32 v65, 0
    v_mov_b32 v66, 0
    v_mov_b32 v67, 0
    v_mov_b32 v68, 0
    v_mov_b32 v69, 0
    v_mov_b32 v70, 0
    v_mov_b32 v71, 0
    v_mov_b32 v72, 0
    v_mov_b32 v73, 0
    v_mov_b32 v74, 0
    v_mov_b32 v75, 0
    v_mov_b32 v76, 0
    v_mov_b32 v77, 0
    v_mov_b32 v78, 0
    v_mov_b32 v79, 0
    v_mov_b32 v80, 0
    v_mov_b32 v81, 0
    v_mov_b32 v82, 0
    v_mov_b32 v83, 0
    v_mov_b32 v84, 0
    v_mov_b32 v85, 0
    v_mov_b32 v86, 0
    v_mov_b32 v87, 0
    v_mov_b32 v88, 0
    v_mov_b32 v89, 0
    v_mov_b32 v90, 0
    v_mov_b32 v91, 0
    v_mov_b32 v92, 0
    v_mov_b32 v93, 0
    v_mov_b32 v94, 0
    v_mov_b32 v95, 0
    v_mov_b32 v96, 0
    v_mov_b32 v97, 0
    v_mov_b32 v98, 0
    v_mov_b32 v99, 0
    v_mov_b32 v100, 0
    v_mov_b32 v101, 0
    v_mov_b32 v102, 0
    v_mov_b32 v103, 0
    v_mov_b32 v104, 0
    v_mov_b32 v105, 0
    v_mov_b32 v106, 0
    v_mov_b32 v107, 0
    v_mov_b32 v108, 0
    v_mov_b32 v109, 0
    v_mov_b32 v110, 0
    v_mov_b32 v111, 0
    s_waitcnt vmcnt(13)
    s_barrier
    ds_read_b128 v[112:115], v4 offset:0
    ds_read_b128 v[116:119], v4 offset:4096
    ds_read_b64_tr_b16 v[144:145], v8 offset:0
    ds_read_b64_tr_b16 v[146:147], v8 offset:512
    ds_read_b64_tr_b16 v[148:149], v8 offset:4096
    ds_read_b64_tr_b16 v[150:151], v8 offset:4608
    ds_read_b64_tr_b16 v[152:153], v8 offset:8192
    ds_read_b64_tr_b16 v[154:155], v8 offset:8704
    s_mov_b32 s3, 0
L_g1_loop:
    s_waitcnt vmcnt(7) lgkmcnt(0)
    s_barrier
    v_mfma_f32_32x32x16_bf16 v[16:31], v[144:147], v[112:115], v[16:31]
    ds_read_b64_tr_b16 v[156:157], v8 offset:2048
    ds_read_b64_tr_b16 v[158:159], v8 offset:2560
    ds_read_b64_tr_b16 v[160:161], v8 offset:6144
    v_mfma_f32_32x32x16_bf16 v[32:47], v[112:115], v[148:151], v[32:47]
    ds_read_b64_tr_b16 v[162:163], v8 offset:6656
    ds_read_b64_tr_b16 v[164:165], v8 offset:10240
    ds_read_b64_tr_b16 v[166:167], v8 offset:10752
    v_mfma_f32_32x32x16_bf16 v[48:63], v[112:115], v[152:155], v[48:63]
    ds_read_b128 v[120:123], v5 offset:0
    ds_read_b128 v[124:127], v5 offset:4096
    ds_read_b128 v[128:131], v6 offset:0
    v_mfma_f32_32x32x16_bf16 v[64:79], v[144:147], v[116:119], v[64:79]
    ds_read_b128 v[132:135], v6 offset:4096
    ds_read_b128 v[136:139], v7 offset:0
    v_mfma_f32_32x32x16_bf16 v[80:95], v[116:119], v[148:151], v[80:95]
    ds_read_b128 v[140:143], v7 offset:4096
    s_add_u32 m0, s63, 36864
    s_add_u32 s30, s28, 2048
    buffer_load_dwordx4 v218, s[8:11], s28 offen lds
    v_mfma_f32_32x32x16_bf16 v[96:111], v[116:119], v[152:155], v[96:111]
    s_add_u32 m0, s63, 40960
    s_add_u32 s31, s28, 4096
    buffer_load_dwordx4 v218, s[8:11], s30 offen lds
    s_add_u32 m0, s63, 45056
    s_add_u32 s28, s28, 196608
    buffer_load_dwordx4 v218, s[8:11], s31 offen lds
    buffer_load_dword v220, v219, s[84:87], s88 offen
    s_add_u32 s88, s88, s89
    s_waitcnt lgkmcnt(0)
    v_mfma_f32_32x32x16_bf16 v[16:31], v[156:159], v[120:123], v[16:31]
    ds_read_b64_tr_b16 v[144:145], v8 offset:12288
    ds_read_b64_tr_b16 v[146:147], v8 offset:12800
    ds_read_b64_tr_b16 v[148:149], v8 offset:16384
    v_mfma_f32_32x32x16_bf16 v[32:47], v[120:123], v[160:163], v[32:47]
    ds_read_b64_tr_b16 v[150:151], v8 offset:16896
    ds_read_b64_tr_b16 v[152:153], v8 offset:20480
    ds_read_b64_tr_b16 v[154:155], v8 offset:20992
    v_mfma_f32_32x32x16_bf16 v[48:63], v[120:123], v[164:167], v[48:63]
    v_mfma_f32_32x32x16_bf16 v[64:79], v[156:159], v[124:127], v[64:79]
    v_mfma_f32_32x32x16_bf16 v[80:95], v[124:127], v[160:163], v[80:95]
    v_mfma_f32_32x32x16_bf16 v[96:111], v[124:127], v[164:167], v[96:111]
    s_waitcnt vmcnt(4) lgkmcnt(0)
    s_barrier
    v_mfma_f32_32x32x16_bf16 v[16:31], v[144:147], v[128:131], v[16:31]
    ds_read_b64_tr_b16 v[156:157], v8 offset:14336
    ds_read_b64_tr_b16 v[158:159], v8 offset:14848
    ds_read_b64_tr_b16 v[160:161], v8 offset:18432
    v_mfma_f32_32x32x16_bf16 v[32:47], v[128:131], v[148:151], v[32:47]
    ds_read_b64_tr_b16 v[162:163], v8 offset:18944
    ds_read_b64_tr_b16 v[164:165], v8 offset:22528
    ds_read_b64_tr_b16 v[166:167], v8 offset:23040
    v_mfma_f32_32x32x16_bf16 v[48:63], v[128:131], v[152:155], v[48:63]
    s_add_u32 m0, s63, 0
    s_add_u32 s30, s28, 2048
    buffer_load_dwordx4 v218, s[8:11], s28 offen lds
    s_add_u32 m0, s63, 4096
    s_add_u32 s31, s28, 4096
    buffer_load_dwordx4 v218, s[8:11], s30 offen lds
    s_add_u32 m0, s63, 8192
    s_add_u32 s28, s28, 196608
    buffer_load_dwordx4 v218, s[8:11], s31 offen lds
    v_mfma_f32_32x32x16_bf16 v[64:79], v[144:147], v[132:135], v[64:79]
    s_add_u32 m0, s62, 0
    s_add_u32 s31, s27, 32768
    buffer_load_dwordx4 v216, s[4:7], s27 offen lds
    s_add_u32 m0, s62, 1024
    s_nop 0
    buffer_load_dwordx4 v217, s[4:7], s27 offen lds
    v_mfma_f32_32x32x16_bf16 v[80:95], v[132:135], v[148:151], v[80:95]
    v_mfma_f32_32x32x16_bf16 v[96:111], v[132:135], v[152:155], v[96:111]
    s_waitcnt lgkmcnt(0)
    v_mfma_f32_32x32x16_bf16 v[16:31], v[156:159], v[136:139], v[16:31]
    ds_read_b64_tr_b16 v[144:145], v8 offset:24576
    ds_read_b64_tr_b16 v[146:147], v8 offset:25088
    ds_read_b64_tr_b16 v[148:149], v8 offset:28672
    v_mfma_f32_32x32x16_bf16 v[32:47], v[136:139], v[160:163], v[32:47]
    ds_read_b64_tr_b16 v[150:151], v8 offset:29184
    ds_read_b64_tr_b16 v[152:153], v8 offset:32768
    ds_read_b64_tr_b16 v[154:155], v8 offset:33280
    v_mfma_f32_32x32x16_bf16 v[48:63], v[136:139], v[164:167], v[48:63]
    ds_read_b128 v[112:115], v4 offset:16384
    ds_read_b128 v[116:119], v4 offset:20480
    s_add_u32 m0, s62, 2048
    s_nop 0
    buffer_load_dwordx4 v216, s[4:7], s31 offen lds
    v_mfma_f32_32x32x16_bf16 v[64:79], v[156:159], v[140:143], v[64:79]
    s_add_u32 m0, s62, 3072
    s_add_u32 s27, s27, 128
    buffer_load_dwordx4 v217, s[4:7], s31 offen lds
    s_cmp_lt_u32 s27, 2048
    s_cselect_b32 s27, s27, 0x10000000
    v_mfma_f32_32x32x16_bf16 v[80:95], v[140:143], v[160:163], v[80:95]
    v_mfma_f32_32x32x16_bf16 v[96:111], v[140:143], v[164:167], v[96:111]
    s_waitcnt vmcnt(8) lgkmcnt(0)
    s_barrier
    v_mfma_f32_32x32x16_bf16 v[16:31], v[144:147], v[112:115], v[16:31]
    ds_read_b64_tr_b16 v[156:157], v8 offset:26624
    ds_read_b64_tr_b16 v[158:159], v8 offset:27136
    ds_read_b64_tr_b16 v[160:161], v8 offset:30720
    v_mfma_f32_32x32x16_bf16 v[32:47], v[112:115], v[148:151], v[32:47]
    ds_read_b64_tr_b16 v[162:163], v8 offset:31232
    ds_read_b64_tr_b16 v[164:165], v8 offset:34816
    ds_read_b64_tr_b16 v[166:167], v8 offset:35328
    v_mfma_f32_32x32x16_bf16 v[48:63], v[112:115], v[152:155], v[48:63]
    ds_read_b128 v[120:123], v5 offset:16384
    ds_read_b128 v[124:127], v5 offset:20480
    ds_read_b128 v[128:131], v6 offset:16384
    v_mfma_f32_32x32x16_bf16 v[64:79], v[144:147], v[116:119], v[64:79]
    ds_read_b128 v[132:135], v6 offset:20480
    ds_read_b128 v[136:139], v7 offset:16384
    v_mfma_f32_32x32x16_bf16 v[80:95], v[116:119], v[148:151], v[80:95]
    ds_read_b128 v[140:143], v7 offset:20480
    s_add_u32 m0, s63, 12288
    s_add_u32 s30, s28, 2048
    buffer_load_dwordx4 v218, s[8:11], s28 offen lds
    v_mfma_f32_32x32x16_bf16 v[96:111], v[116:119], v[152:155], v[96:111]
    s_add_u32 m0, s63, 16384
    s_add_u32 s31, s28, 4096
    buffer_load_dwordx4 v218, s[8:11], s30 offen lds
    s_add_u32 m0, s63, 20480
    s_add_u32 s28, s28, 196608
    buffer_load_dwordx4 v218, s[8:11], s31 offen lds
    s_waitcnt lgkmcnt(0)
    v_mfma_f32_32x32x16_bf16 v[16:31], v[156:159], v[120:123], v[16:31]
    ds_read_b64_tr_b16 v[144:145], v8 offset:36864
    ds_read_b64_tr_b16 v[146:147], v8 offset:37376
    ds_read_b64_tr_b16 v[148:149], v8 offset:40960
    v_mfma_f32_32x32x16_bf16 v[32:47], v[120:123], v[160:163], v[32:47]
    ds_read_b64_tr_b16 v[150:151], v8 offset:41472
    ds_read_b64_tr_b16 v[152:153], v8 offset:45056
    ds_read_b64_tr_b16 v[154:155], v8 offset:45568
    v_mfma_f32_32x32x16_bf16 v[48:63], v[120:123], v[164:167], v[48:63]
    v_mfma_f32_32x32x16_bf16 v[64:79], v[156:159], v[124:127], v[64:79]
    v_mfma_f32_32x32x16_bf16 v[80:95], v[124:127], v[160:163], v[80:95]
    v_mfma_f32_32x32x16_bf16 v[96:111], v[124:127], v[164:167], v[96:111]
    s_waitcnt vmcnt(3) lgkmcnt(0)
    s_barrier
    v_mfma_f32_32x32x16_bf16 v[16:31], v[144:147], v[128:131], v[16:31]
    ds_read_b64_tr_b16 v[156:157], v8 offset:38912
    ds_read_b64_tr_b16 v[158:159], v8 offset:39424
    ds_read_b64_tr_b16 v[160:161], v8 offset:43008
    v_mfma_f32_32x32x16_bf16 v[32:47], v[128:131], v[148:151], v[32:47]
    ds_read_b64_tr_b16 v[162:163], v8 offset:43520
    ds_read_b64_tr_b16 v[164:165], v8 offset:47104
    ds_read_b64_tr_b16 v[166:167], v8 offset:47616
    v_mfma_f32_32x32x16_bf16 v[48:63], v[128:131], v[152:155], v[48:63]
    s_add_u32 m0, s63, 24576
    s_add_u32 s30, s28, 2048
    buffer_load_dwordx4 v218, s[8:11], s28 offen lds
    s_add_u32 m0, s63, 28672
    s_add_u32 s31, s28, 4096
    buffer_load_dwordx4 v218, s[8:11], s30 offen lds
    s_add_u32 m0, s63, 32768
    s_add_u32 s28, s28, 196608
    buffer_load_dwordx4 v218, s[8:11], s31 offen lds
    v_mfma_f32_32x32x16_bf16 v[64:79], v[144:147], v[132:135], v[64:79]
    s_add_u32 m0, s62, 16384
    s_add_u32 s31, s27, 32768
    buffer_load_dwordx4 v216, s[4:7], s27 offen lds
    s_add_u32 m0, s62, 17408
    s_nop 0
    buffer_load_dwordx4 v217, s[4:7], s27 offen lds
    v_mfma_f32_32x32x16_bf16 v[80:95], v[132:135], v[148:151], v[80:95]
    v_mfma_f32_32x32x16_bf16 v[96:111], v[132:135], v[152:155], v[96:111]
    s_waitcnt lgkmcnt(0)
    v_mfma_f32_32x32x16_bf16 v[16:31], v[156:159], v[136:139], v[16:31]
    ds_read_b64_tr_b16 v[144:145], v8 offset:0
    ds_read_b64_tr_b16 v[146:147], v8 offset:512
    ds_read_b64_tr_b16 v[148:149], v8 offset:4096
    v_mfma_f32_32x32x16_bf16 v[32:47], v[136:139], v[160:163], v[32:47]
    ds_read_b64_tr_b16 v[150:151], v8 offset:4608
    ds_read_b64_tr_b16 v[152:153], v8 offset:8192
    ds_read_b64_tr_b16 v[154:155], v8 offset:8704
    v_mfma_f32_32x32x16_bf16 v[48:63], v[136:139], v[164:167], v[48:63]
    ds_read_b128 v[112:115], v4 offset:0
    ds_read_b128 v[116:119], v4 offset:4096
    s_add_u32 m0, s62, 18432
    s_nop 0
    buffer_load_dwordx4 v216, s[4:7], s31 offen lds
    v_mfma_f32_32x32x16_bf16 v[64:79], v[156:159], v[140:143], v[64:79]
    s_add_u32 m0, s62, 19456
    s_add_u32 s27, s27, 128
    buffer_load_dwordx4 v217, s[4:7], s31 offen lds
    s_cmp_lt_u32 s27, 2048
    s_cselect_b32 s27, s27, 0x10000000
    v_mfma_f32_32x32x16_bf16 v[80:95], v[140:143], v[160:163], v[80:95]
    v_mfma_f32_32x32x16_bf16 v[96:111], v[140:143], v[164:167], v[96:111]
    s_add_u32 s3, s3, 1
    s_cmp_lt_u32 s3, 8
    s_cbranch_scc1 L_g1_loop
    s_waitcnt vmcnt(0) lgkmcnt(0)
    s_mov_b32 s40, 0x3fb8aa3b
    s_mov_b32 s41, 0x3fb8aa3b
    s_mov_b32 s42, 0x358637bd
    s_mov_b32 s43, 0x358637bd
    s_lshl_b32 s44, s19, 1
    s_add_u32 s44, s44, s24
    v_lshlrev_b32 v10, 4, v1
    v_mov_b32 v12, 0x3f803f80
    v_mov_b32 v13, 0x3f803f80
    v_mov_b32 v14, 0x3f803f80
    v_mov_b32 v15, 0x3f803f80
    v_pk_mul_f32 v[152:153], v[32:33], s[40:41]
    v_max_f32 v154, 0, v32
    v_max_f32 v155, 0, v33
    v_exp_f32_e64 v152, v152 clamp
    v_exp_f32_e64 v153, v153 clamp
    v_pk_add_f32 v[154:155], v[154:155], s[42:43]
    v_pk_add_f32 v[152:153], v[152:153], v[154:155]
    v_cvt_pk_bf16_f32 v160, v152, v153
    v_pk_mul_f32 v[156:157], v[34:35], s[40:41]
    v_max_f32 v158, 0, v34
    v_max_f32 v159, 0, v35
    v_exp_f32_e64 v156, v156 clamp
    v_exp_f32_e64 v157, v157 clamp
    v_pk_add_f32 v[158:159], v[158:159], s[42:43]
    v_pk_add_f32 v[156:157], v[156:157], v[158:159]
    v_cvt_pk_bf16_f32 v161, v156, v157
    v_pk_mul_f32 v[152:153], v[36:37], s[40:41]
    v_max_f32 v154, 0, v36
    v_max_f32 v155, 0, v37
    v_exp_f32_e64 v152, v152 clamp
    v_exp_f32_e64 v153, v153 clamp
    v_pk_add_f32 v[154:155], v[154:155], s[42:43]
    v_pk_add_f32 v[152:153], v[152:153], v[154:155]
    v_cvt_pk_bf16_f32 v162, v152, v153
    v_pk_mul_f32 v[156:157], v[38:39], s[40:41]
    v_max_f32 v158, 0, v38
    v_max_f32 v159, 0, v39
    v_exp_f32_e64 v156, v156 clamp
    v_exp_f32_e64 v157, v157 clamp
    v_pk_add_f32 v[158:159], v[158:159], s[42:43]
    v_pk_add_f32 v[156:157], v[156:157], v[158:159]
    v_cvt_pk_bf16_f32 v163, v156, v157
    v_pk_mul_f32 v[152:153], v[40:41], s[40:41]
    v_max_f32 v154, 0, v40
    v_max_f32 v155, 0, v41
    v_exp_f32_e64 v152, v152 clamp
    v_exp_f32_e64 v153, v153 clamp
    v_pk_add_f32 v[154:155], v[154:155], s[42:43]
    v_pk_add_f32 v[152:153], v[152:153], v[154:155]
    v_cvt_pk_bf16_f32 v164, v152, v153
    v_pk_mul_f32 v[156:157], v[42:43], s[40:41]
    v_max_f32 v158, 0, v42
    v_max_f32 v159, 0, v43
    v_exp_f32_e64 v156, v156 clamp
    v_exp_f32_e64 v157, v157 clamp
    v_pk_add_f32 v[158:159], v[158:159], s[42:43]
    v_pk_add_f32 v[156:157], v[156:157], v[158:159]
    v_cvt_pk_bf16_f32 v165, v156, v157
    v_pk_mul_f32 v[152:153], v[44:45], s[40:41]
    v_max_f32 v154, 0, v44
    v_max_f32 v155, 0, v45
    v_exp_f32_e64 v152, v152 clamp
    v_exp_f32_e64 v153, v153 clamp
    v_pk_add_f32 v[154:155], v[154:155], s[42:43]
    v_pk_add_f32 v[152:153], v[152:153], v[154:155]
    v_cvt_pk_bf16_f32 v166, v152, v153
    v_pk_mul_f32 v[156:157], v[46:47], s[40:41]
    v_max_f32 v158, 0, v46
    v_max_f32 v159, 0, v47
    v_exp_f32_e64 v156, v156 clamp
    v_exp_f32_e64 v157, v157 clamp
    v_pk_add_f32 v[158:159], v[158:159], s[42:43]
    v_pk_add_f32 v[156:157], v[156:157], v[158:159]
    v_cvt_pk_bf16_f32 v167, v156, v157
    v_cvt_pk_bf16_f32 v168, v48, v49
    v_cvt_pk_bf16_f32 v169, v50, v51
    v_cvt_pk_bf16_f32 v170, v52, v53
    v_cvt_pk_bf16_f32 v171, v54, v55
    v_cvt_pk_bf16_f32 v172, v56, v57
    v_cvt_pk_bf16_f32 v173, v58, v59
    v_cvt_pk_bf16_f32 v174, v60, v61
    v_cvt_pk_bf16_f32 v175, v62, v63
    v_mfma_f32_32x32x16_bf16 v[112:127], v[160:163], v[168:171], 0
    v_mfma_f32_32x32x16_bf16 v[128:143], v[160:163], v[12:15], 0
    v_mfma_f32_32x32x16_bf16 v[112:127], v[164:167], v[172:175], v[112:127]
    v_mfma_f32_32x32x16_bf16 v[128:143], v[164:167], v[12:15], v[128:143]
    v_pk_mul_f32 v[152:153], v[16:17], s[40:41]
    v_max_f32 v154, 0, v16
    v_max_f32 v155, 0, v17
    v_exp_f32_e64 v152, v152 clamp
    v_exp_f32_e64 v153, v153 clamp
    v_pk_add_f32 v[154:155], v[154:155], s[42:43]
    v_pk_add_f32 v[152:153], v[152:153], v[154:155]
    v_cvt_pk_bf16_f32 v176, v152, v153
    v_pk_mul_f32 v[156:157], v[18:19], s[40:41]
    v_max_f32 v158, 0, v18
    v_max_f32 v159, 0, v19
    v_exp_f32_e64 v156, v156 clamp
    v_exp_f32_e64 v157, v157 clamp
    v_pk_add_f32 v[158:159], v[158:159], s[42:43]
    v_pk_add_f32 v[156:157], v[156:157], v[158:159]
    v_cvt_pk_bf16_f32 v177, v156, v157
    v_pk_mul_f32 v[152:153], v[20:21], s[40:41]
    v_max_f32 v154, 0, v20
    v_max_f32 v155, 0, v21
    v_exp_f32_e64 v152, v152 clamp
    v_exp_f32_e64 v153, v153 clamp
    v_pk_add_f32 v[154:155], v[154:155], s[42:43]
    v_pk_add_f32 v[152:153], v[152:153], v[154:155]
    v_cvt_pk_bf16_f32 v178, v152, v153
    v_pk_mul_f32 v[156:157], v[22:23], s[40:41]
    v_max_f32 v158, 0, v22
    v_max_f32 v159, 0, v23
    v_exp_f32_e64 v156, v156 clamp
    v_exp_f32_e64 v157, v157 clamp
    v_pk_add_f32 v[158:159], v[158:159], s[42:43]
    v_pk_add_f32 v[156:157], v[156:157], v[158:159]
    v_cvt_pk_bf16_f32 v179, v156, v157
    v_pk_mul_f32 v[152:153], v[24:25], s[40:41]
    v_max_f32 v154, 0, v24
    v_max_f32 v155, 0, v25
    v_exp_f32_e64 v152, v152 clamp
    v_exp_f32_e64 v153, v153 clamp
    v_pk_add_f32 v[154:155], v[154:155], s[42:43]
    v_pk_add_f32 v[152:153], v[152:153], v[154:155]
    v_cvt_pk_bf16_f32 v180, v152, v153
    v_pk_mul_f32 v[156:157], v[26:27], s[40:41]
    v_max_f32 v158, 0, v26
    v_max_f32 v159, 0, v27
    v_exp_f32_e64 v156, v156 clamp
    v_exp_f32_e64 v157, v157 clamp
    v_pk_add_f32 v[158:159], v[158:159], s[42:43]
    v_pk_add_f32 v[156:157], v[156:157], v[158:159]
    v_cvt_pk_bf16_f32 v181, v156, v157
    v_pk_mul_f32 v[152:153], v[28:29], s[40:41]
    v_max_f32 v154, 0, v28
    v_max_f32 v155, 0, v29
    v_exp_f32_e64 v152, v152 clamp
    v_exp_f32_e64 v153, v153 clamp
    v_pk_add_f32 v[154:155], v[154:155], s[42:43]
    v_pk_add_f32 v[152:153], v[152:153], v[154:155]
    v_cvt_pk_bf16_f32 v182, v152, v153
    v_pk_mul_f32 v[156:157], v[30:31], s[40:41]
    v_max_f32 v158, 0, v30
    v_max_f32 v159, 0, v31
    v_exp_f32_e64 v156, v156 clamp
    v_exp_f32_e64 v157, v157 clamp
    v_pk_add_f32 v[158:159], v[158:159], s[42:43]
    v_pk_add_f32 v[156:157], v[156:157], v[158:159]
    v_cvt_pk_bf16_f32 v183, v156, v157
    s_lshl_b32 s45, s18, 2
    s_lshl_b32 s46, s23, 1
    s_add_u32 s45, s45, s46
    s_add_u32 s45, s45, 0
    s_lshl_b32 s45, s45, 5
    s_add_u32 s45, s45, s44
    s_lshl_b32 s45, s45, 11
    s_add_u32 s45, s45, 0
    buffer_store_dwordx4 v[176:179], v10, s[12:15], s45 offen
    buffer_store_dwordx4 v[180:183], v10, s[12:15], s45 offen offset:1024
    v_pk_mul_f32 v[152:153], v[80:81], s[40:41]
    v_max_f32 v154, 0, v80
    v_max_f32 v155, 0, v81
    v_exp_f32_e64 v152, v152 clamp
    v_exp_f32_e64 v153, v153 clamp
    v_pk_add_f32 v[154:155], v[154:155], s[42:43]
    v_pk_add_f32 v[152:153], v[152:153], v[154:155]
    v_cvt_pk_bf16_f32 v160, v152, v153
    v_pk_mul_f32 v[156:157], v[82:83], s[40:41]
    v_max_f32 v158, 0, v82
    v_max_f32 v159, 0, v83
    v_exp_f32_e64 v156, v156 clamp
    v_exp_f32_e64 v157, v157 clamp
    v_pk_add_f32 v[158:159], v[158:159], s[42:43]
    v_pk_add_f32 v[156:157], v[156:157], v[158:159]
    v_cvt_pk_bf16_f32 v161, v156, v157
    v_pk_mul_f32 v[152:153], v[84:85], s[40:41]
    v_max_f32 v154, 0, v84
    v_max_f32 v155, 0, v85
    v_exp_f32_e64 v152, v152 clamp
    v_exp_f32_e64 v153, v153 clamp
    v_pk_add_f32 v[154:155], v[154:155], s[42:43]
    v_pk_add_f32 v[152:153], v[152:153], v[154:155]
    v_cvt_pk_bf16_f32 v162, v152, v153
    v_pk_mul_f32 v[156:157], v[86:87], s[40:41]
    v_max_f32 v158, 0, v86
    v_max_f32 v159, 0, v87
    v_exp_f32_e64 v156, v156 clamp
    v_exp_f32_e64 v157, v157 clamp
    v_pk_add_f32 v[158:159], v[158:159], s[42:43]
    v_pk_add_f32 v[156:157], v[156:157], v[158:159]
    v_cvt_pk_bf16_f32 v163, v156, v157
    v_pk_mul_f32 v[152:153], v[88:89], s[40:41]
    v_max_f32 v154, 0, v88
    v_max_f32 v155, 0, v89
    v_exp_f32_e64 v152, v152 clamp
    v_exp_f32_e64 v153, v153 clamp
    v_pk_add_f32 v[154:155], v[154:155], s[42:43]
    v_pk_add_f32 v[152:153], v[152:153], v[154:155]
    v_cvt_pk_bf16_f32 v164, v152, v153
    v_pk_mul_f32 v[156:157], v[90:91], s[40:41]
    v_max_f32 v158, 0, v90
    v_max_f32 v159, 0, v91
    v_exp_f32_e64 v156, v156 clamp
    v_exp_f32_e64 v157, v157 clamp
    v_pk_add_f32 v[158:159], v[158:159], s[42:43]
    v_pk_add_f32 v[156:157], v[156:157], v[158:159]
    v_cvt_pk_bf16_f32 v165, v156, v157
    v_pk_mul_f32 v[152:153], v[92:93], s[40:41]
    v_max_f32 v154, 0, v92
    v_max_f32 v155, 0, v93
    v_exp_f32_e64 v152, v152 clamp
    v_exp_f32_e64 v153, v153 clamp
    v_pk_add_f32 v[154:155], v[154:155], s[42:43]
    v_pk_add_f32 v[152:153], v[152:153], v[154:155]
    v_cvt_pk_bf16_f32 v166, v152, v153
    v_pk_mul_f32 v[156:157], v[94:95], s[40:41]
    v_max_f32 v158, 0, v94
    v_max_f32 v159, 0, v95
    v_exp_f32_e64 v156, v156 clamp
    v_exp_f32_e64 v157, v157 clamp
    v_pk_add_f32 v[158:159], v[158:159], s[42:43]
    v_pk_add_f32 v[156:157], v[156:157], v[158:159]
    v_cvt_pk_bf16_f32 v167, v156, v157
    v_cvt_pk_bf16_f32 v168, v96, v97
    v_cvt_pk_bf16_f32 v169, v98, v99
    v_cvt_pk_bf16_f32 v170, v100, v101
    v_cvt_pk_bf16_f32 v171, v102, v103
    v_cvt_pk_bf16_f32 v172, v104, v105
    v_cvt_pk_bf16_f32 v173, v106, v107
    v_cvt_pk_bf16_f32 v174, v108, v109
    v_cvt_pk_bf16_f32 v175, v110, v111
    v_mfma_f32_32x32x16_bf16 v[112:127], v[160:163], v[168:171], v[112:127]
    v_mfma_f32_32x32x16_bf16 v[128:143], v[160:163], v[12:15], v[128:143]
    v_mfma_f32_32x32x16_bf16 v[112:127], v[164:167], v[172:175], v[112:127]
    v_mfma_f32_32x32x16_bf16 v[128:143], v[164:167], v[12:15], v[128:143]
    v_pk_mul_f32 v[152:153], v[64:65], s[40:41]
    v_max_f32 v154, 0, v64
    v_max_f32 v155, 0, v65
    v_exp_f32_e64 v152, v152 clamp
    v_exp_f32_e64 v153, v153 clamp
    v_pk_add_f32 v[154:155], v[154:155], s[42:43]
    v_pk_add_f32 v[152:153], v[152:153], v[154:155]
    v_cvt_pk_bf16_f32 v176, v152, v153
    v_pk_mul_f32 v[156:157], v[66:67], s[40:41]
    v_max_f32 v158, 0, v66
    v_max_f32 v159, 0, v67
    v_exp_f32_e64 v156, v156 clamp
    v_exp_f32_e64 v157, v157 clamp
    v_pk_add_f32 v[158:159], v[158:159], s[42:43]
    v_pk_add_f32 v[156:157], v[156:157], v[158:159]
    v_cvt_pk_bf16_f32 v177, v156, v157
    v_pk_mul_f32 v[152:153], v[68:69], s[40:41]
    v_max_f32 v154, 0, v68
    v_max_f32 v155, 0, v69
    v_exp_f32_e64 v152, v152 clamp
    v_exp_f32_e64 v153, v153 clamp
    v_pk_add_f32 v[154:155], v[154:155], s[42:43]
    v_pk_add_f32 v[152:153], v[152:153], v[154:155]
    v_cvt_pk_bf16_f32 v178, v152, v153
    v_pk_mul_f32 v[156:157], v[70:71], s[40:41]
    v_max_f32 v158, 0, v70
    v_max_f32 v159, 0, v71
    v_exp_f32_e64 v156, v156 clamp
    v_exp_f32_e64 v157, v157 clamp
    v_pk_add_f32 v[158:159], v[158:159], s[42:43]
    v_pk_add_f32 v[156:157], v[156:157], v[158:159]
    v_cvt_pk_bf16_f32 v179, v156, v157
    v_pk_mul_f32 v[152:153], v[72:73], s[40:41]
    v_max_f32 v154, 0, v72
    v_max_f32 v155, 0, v73
    v_exp_f32_e64 v152, v152 clamp
    v_exp_f32_e64 v153, v153 clamp
    v_pk_add_f32 v[154:155], v[154:155], s[42:43]
    v_pk_add_f32 v[152:153], v[152:153], v[154:155]
    v_cvt_pk_bf16_f32 v180, v152, v153
    v_pk_mul_f32 v[156:157], v[74:75], s[40:41]
    v_max_f32 v158, 0, v74
    v_max_f32 v159, 0, v75
    v_exp_f32_e64 v156, v156 clamp
    v_exp_f32_e64 v157, v157 clamp
    v_pk_add_f32 v[158:159], v[158:159], s[42:43]
    v_pk_add_f32 v[156:157], v[156:157], v[158:159]
    v_cvt_pk_bf16_f32 v181, v156, v157
    v_pk_mul_f32 v[152:153], v[76:77], s[40:41]
    v_max_f32 v154, 0, v76
    v_max_f32 v155, 0, v77
    v_exp_f32_e64 v152, v152 clamp
    v_exp_f32_e64 v153, v153 clamp
    v_pk_add_f32 v[154:155], v[154:155], s[42:43]
    v_pk_add_f32 v[152:153], v[152:153], v[154:155]
    v_cvt_pk_bf16_f32 v182, v152, v153
    v_pk_mul_f32 v[156:157], v[78:79], s[40:41]
    v_max_f32 v158, 0, v78
    v_max_f32 v159, 0, v79
    v_exp_f32_e64 v156, v156 clamp
    v_exp_f32_e64 v157, v157 clamp
    v_pk_add_f32 v[158:159], v[158:159], s[42:43]
    v_pk_add_f32 v[156:157], v[156:157], v[158:159]
    v_cvt_pk_bf16_f32 v183, v156, v157
    s_lshl_b32 s45, s18, 2
    s_lshl_b32 s46, s23, 1
    s_add_u32 s45, s45, s46
    s_add_u32 s45, s45, 1
    s_lshl_b32 s45, s45, 5
    s_add_u32 s45, s45, s44
    s_lshl_b32 s45, s45, 11
    s_add_u32 s45, s45, 0
    buffer_store_dwordx4 v[176:179], v10, s[12:15], s45 offen
    buffer_store_dwordx4 v[180:183], v10, s[12:15], s45 offen offset:1024
    s_barrier
    s_lshl_b32 s45, s24, 13
    v_add_u32 v11, s45, v10
    s_cmp_eq_u32 s23, 0
    s_cbranch_scc1 L_g1_red_wait
    ds_write_b128 v11, v[112:115] offset:0
    ds_write_b128 v11, v[116:119] offset:1024
    ds_write_b128 v11, v[120:123] offset:2048
    ds_write_b128 v11, v[124:127] offset:3072
    ds_write_b128 v11, v[128:131] offset:4096
    ds_write_b128 v11, v[132:135] offset:5120
    ds_write_b128 v11, v[136:139] offset:6144
    ds_write_b128 v11, v[140:143] offset:7168
    s_waitcnt lgkmcnt(0)
    s_barrier
    s_endpgm
L_g1_red_wait:
    s_barrier
    ds_read_b128 v[16:19], v11 offset:0
    ds_read_b128 v[20:23], v11 offset:1024
    ds_read_b128 v[24:27], v11 offset:2048
    ds_read_b128 v[28:31], v11 offset:3072
    ds_read_b128 v[32:35], v11 offset:4096
    ds_read_b128 v[36:39], v11 offset:5120
    ds_read_b128 v[40:43], v11 offset:6144
    ds_read_b128 v[44:47], v11 offset:7168
    s_waitcnt lgkmcnt(0)
    v_pk_add_f32 v[112:113], v[112:113], v[16:17]
    v_pk_add_f32 v[114:115], v[114:115], v[18:19]
    v_pk_add_f32 v[116:117], v[116:117], v[20:21]
    v_pk_add_f32 v[118:119], v[118:119], v[22:23]
    v_pk_add_f32 v[120:121], v[120:121], v[24:25]
    v_pk_add_f32 v[122:123], v[122:123], v[26:27]
    v_pk_add_f32 v[124:125], v[124:125], v[28:29]
    v_pk_add_f32 v[126:127], v[126:127], v[30:31]
    v_pk_add_f32 v[128:129], v[128:129], v[32:33]
    v_pk_add_f32 v[130:131], v[130:131], v[34:35]
    v_pk_add_f32 v[132:133], v[132:133], v[36:37]
    v_pk_add_f32 v[134:135], v[134:135], v[38:39]
    v_pk_add_f32 v[136:137], v[136:137], v[40:41]
    v_pk_add_f32 v[138:139], v[138:139], v[42:43]
    v_pk_add_f32 v[140:141], v[140:141], v[44:45]
    v_pk_add_f32 v[142:143], v[142:143], v[46:47]
    s_lshl_b32 s45, s44, 4
    s_add_u32 s45, s45, s18
    s_lshl_b32 s46, s45, 12
    s_add_u32 s46, s46, 4194304
    s_lshl_b32 s47, s45, 7
    s_add_u32 s47, s47, 6291456
    buffer_store_dwordx4 v[112:115], v10, s[12:15], s46 offen offset:0
    buffer_store_dwordx4 v[116:119], v10, s[12:15], s46 offen offset:1024
    buffer_store_dwordx4 v[120:123], v10, s[12:15], s46 offen offset:2048
    buffer_store_dwordx4 v[124:127], v10, s[12:15], s46 offen offset:3072
    v_and_b32 v11, 31, v1
    v_lshlrev_b32 v12, 1, v1
    v_cmp_eq_u32 vcc, 0, v11
    s_nop 0
    s_and_saveexec_b64 s[48:49], vcc
    buffer_store_dwordx4 v[128:131], v12, s[12:15], s47 offen offset:0
    buffer_store_dwordx4 v[132:135], v12, s[12:15], s47 offen offset:16
    buffer_store_dwordx4 v[136:139], v12, s[12:15], s47 offen offset:32
    buffer_store_dwordx4 v[140:143], v12, s[12:15], s47 offen offset:48
    s_endpgm
L_k1_aux:
    s_sub_u32 s16, s2, 256
    v_lshlrev_b32 v2, 6, v1
    v_mov_b32 v3, 0
    s_mov_b32 s20, 27262976
    s_or_b32 s21, s16, s22
    s_cmp_lg_u32 s21, 0
    s_cbranch_scc1 L_k1_noflag
    buffer_store_dword v3, v2, s[12:15], s20 offen
L_k1_noflag:
    s_lshl_b32 s25, s16, 2
    s_add_u32 s25, s25, s22
    s_lshl_b32 s26, s25, 8
    v_lshlrev_b32 v7, 1, v1
    s_mov_b32 s46, 0x40000
    s_mov_b32 s47, 0x00020000
    s_mov_b32 s44, s48
    s_mov_b32 s45, s49
    buffer_load_ushort v32, v7, s[44:47], s26 offen
    buffer_load_ushort v33, v7, s[44:47], s26 offen offset:128
    s_mov_b32 s44, s50
    s_mov_b32 s45, s51
    buffer_load_ushort v34, v7, s[44:47], s26 offen
    buffer_load_ushort v35, v7, s[44:47], s26 offen offset:128
    s_mov_b32 s44, s52
    s_mov_b32 s45, s53
    buffer_load_ushort v36, v7, s[44:47], s26 offen
    buffer_load_ushort v37, v7, s[44:47], s26 offen offset:128
    s_mov_b32 s44, s54
    s_mov_b32 s45, s55
    buffer_load_ushort v38, v7, s[44:47], s26 offen
    buffer_load_ushort v39, v7, s[44:47], s26 offen offset:128
    s_mov_b32 s44, s56
    s_mov_b32 s45, s57
    s_mov_b32 s46, 2048
    s_lshl_b32 s20, s25, 1
    v_mov_b32 v8, s20
    buffer_load_ushort v40, v8, s[44:47], 0 offen
    s_mul_i32 s26, s22, 6912
    s_mov_b32 s40, 0x3fb8aa3b
    s_mov_b32 s41, 849703008
    s_mov_b32 s42, 1060205080
    s_mov_b32 s43, 1042479491
    s_waitcnt vmcnt(0)
    v_lshlrev_b32 v32, 16, v32
    v_lshlrev_b32 v33, 16, v33
    v_lshlrev_b32 v34, 16, v34
    v_lshlrev_b32 v35, 16, v35
    v_lshlrev_b32 v36, 16, v36
    v_lshlrev_b32 v37, 16, v37
    v_lshlrev_b32 v38, 16, v38
    v_lshlrev_b32 v39, 16, v39
    v_lshlrev_b32 v40, 16, v40
    v_mul_f32 v56, s40, v40
    v_fma_f32 v57, v40, s40, -v56
    v_fma_f32 v57, v40, s41, v57
    v_exp_f32 v56, v56
    v_mul_f32 v57, s42, v57
    v_fma_f32 v56, v56, v57, v56
    v_cvt_pk_bf16_f32 v56, v56, v56
    v_lshlrev_b32 v40, 16, v56
    v_mul_f32 v58, s40, v32
    v_fma_f32 v59, v32, s40, -v58
    v_fma_f32 v59, v32, s41, v59
    v_exp_f32 v58, v58
    v_mul_f32 v59, s42, v59
    v_fma_f32 v58, v58, v59, v58
    v_cvt_pk_bf16_f32 v58, v58, v58
    v_lshlrev_b32 v32, 16, v58
    v_mul_f32 v60, s40, v33
    v_fma_f32 v61, v33, s40, -v60
    v_fma_f32 v61, v33, s41, v61
    v_exp_f32 v60, v60
    v_mul_f32 v61, s42, v61
    v_fma_f32 v60, v60, v61, v60
    v_cvt_pk_bf16_f32 v60, v60, v60
    v_lshlrev_b32 v33, 16, v60
    v_max_f32_e64 v44, |v36|, |v37|
    v_max3_f32 v44, |v38|, |v39|, v44
    s_nop 1
    v_max_f32_dpp v44, v44, v44 row_ror:1 row_mask:0xf bank_mask:0xf
    s_nop 1
    v_max_f32_dpp v44, v44, v44 row_ror:2 row_mask:0xf bank_mask:0xf
    s_nop 1
    v_max_f32_dpp v44, v44, v44 row_ror:4 row_mask:0xf bank_mask:0xf
    s_nop 1
    v_max_f32_dpp v44, v44, v44 row_ror:8 row_mask:0xf bank_mask:0xf
    s_nop 1
    v_readlane_b32 s32, v44, 0
    v_readlane_b32 s33, v44, 16
    v_readlane_b32 s34, v44, 32
    v_readlane_b32 s35, v44, 48
    s_nop 1
    s_max_u32 s32, s32, s33
    s_max_u32 s34, s34, s35
    s_max_u32 s32, s32, s34
    s_lshr_b32 s32, s32, 23
    s_min_u32 s32, s32, 252
    s_sub_u32 s33, 253, s32
    s_lshl_b32 s33, s33, 23
    s_add_u32 s32, s32, 1
    s_lshl_b32 s32, s32, 23
    v_add_f32 v46, v40, v40
    v_mul_f32 v111, s32, v46
    v_mul_f32 v48, v32, v40
    v_mul_f32 v49, v34, v40
    v_mul_f32 v50, s33, v36
    v_mul_f32 v51, s33, v38
    v_mul_f32 v48, s40, v48
    v_mul_f32 v49, s43, v49
    v_sub_f32 v48, 0, v48
    v_mul_f32 v52, v33, v40
    v_mul_f32 v53, v35, v40
    v_mul_f32 v54, s33, v37
    v_mul_f32 v55, s33, v39
    v_mul_f32 v52, s40, v52
    v_mul_f32 v53, s43, v53
    v_sub_f32 v52, 0, v52
    v_lshlrev_b32 v2, 4, v1
    v_add_u32 v2, s26, v2
    ds_write_b128 v2, v[48:51]
    ds_write_b128 v2, v[52:55] offset:1024
    v_and_b32 v3, 15, v1
    v_lshrrev_b32 v4, 4, v1
    v_and_b32 v5, 7, v3
    v_lshrrev_b32 v6, 3, v3
    v_lshl_add_u32 v8, v6, 7, v5
    v_and_b32 v6, 3, v3
    v_lshlrev_b32 v6, 1, v6
    v_lshrrev_b32 v7, 2, v3
    v_lshl_add_u32 v6, v7, 7, v6
    v_add_u32 v6, 256, v6
    v_and_b32 v7, 1, v3
    v_lshlrev_b32 v7, 2, v7
    v_lshrrev_b32 v9, 1, v3
    v_and_b32 v9, 3, v9
    v_lshl_add_u32 v7, v9, 7, v7
    v_add_u32 v7, 512, v7
    v_cmp_gt_u32 vcc, 8, v3
    s_nop 1
    v_cndmask_b32 v10, v7, v6, vcc
    v_lshlrev_b32 v7, 7, v3
    v_add_u32 v7, 1024, v7
    v_min_u32 v12, 2176, v7
    v_lshlrev_b32 v6, 2, v3
    v_add_u32 v6, s26, v6
    ds_write_b32 v6, v8 offset:6656
    ds_write_b32 v6, v10 offset:6720
    ds_write_b32 v6, v12 offset:6784
    v_cvt_f32_u32 v8, v8
    v_cvt_f32_u32 v10, v10
    v_cvt_f32_u32 v12, v12
    v_mov_b32 v9, v8
    v_mov_b32 v11, v10
    v_mov_b32 v13, v12
    v_lshlrev_b32 v14, 3, v3
    v_cvt_f32_u32 v14, v14
    v_mov_b32 v15, v14
    v_lshlrev_b32 v7, 6, v4
    v_add_u32 v7, s26, v7
    v_mov_b32 v96, 0
    v_mov_b32 v97, 0
    v_mov_b32 v98, 0
    v_mov_b32 v99, 0
    v_mov_b32 v100, 0
    v_mov_b32 v101, 0
    v_mov_b32 v102, 0
    v_mov_b32 v103, 0
    v_mov_b32 v104, 0
    v_mov_b32 v105, 0
    v_mov_b32 v106, 0
    v_mov_b32 v107, 0
    s_mov_b32 s21, 0
    s_waitcnt lgkmcnt(0)
L_kg_loop:
    ds_read_b128 v[16:19], v7 offset:0
    ds_read_b128 v[20:23], v7 offset:16
    ds_read_b128 v[24:27], v7 offset:32
    ds_read_b128 v[28:31], v7 offset:48
    v_add_u32 v7, 256, v7
    s_waitcnt lgkmcnt(0)
    v_pk_mul_f32 v[32:33], v[16:17], v[14:15]
    v_pk_mul_f32 v[36:37], v[20:21], v[14:15]
    v_pk_mul_f32 v[40:41], v[24:25], v[14:15]
    v_pk_mul_f32 v[44:45], v[28:29], v[14:15]
    v_fract_f32 v33, v33
    v_fract_f32 v37, v37
    v_fract_f32 v41, v41
    v_fract_f32 v45, v45
    v_exp_f32 v32, v32
    v_exp_f32 v36, v36
    v_exp_f32 v40, v40
    v_exp_f32 v44, v44
    v_cos_f32 v34, v33
    v_cos_f32 v38, v37
    v_cos_f32 v42, v41
    v_cos_f32 v46, v45
    v_sin_f32 v35, v33
    v_sin_f32 v39, v37
    v_sin_f32 v43, v41
    v_sin_f32 v47, v45
    v_pk_mul_f32 v[34:35], v[34:35], v[32:33] op_sel_hi:[1,0]
    v_pk_mul_f32 v[38:39], v[38:39], v[36:37] op_sel_hi:[1,0]
    v_pk_mul_f32 v[42:43], v[42:43], v[40:41] op_sel_hi:[1,0]
    v_pk_mul_f32 v[46:47], v[46:47], v[44:45] op_sel_hi:[1,0]
    v_pk_mul_f32 v[32:33], v[34:35], v[18:19] op_sel_hi:[1,0] neg_hi:[0,1]
    v_pk_mul_f32 v[36:37], v[38:39], v[22:23] op_sel_hi:[1,0] neg_hi:[0,1]
    v_pk_mul_f32 v[40:41], v[42:43], v[26:27] op_sel_hi:[1,0] neg_hi:[0,1]
    v_pk_mul_f32 v[44:45], v[46:47], v[30:31] op_sel_hi:[1,0] neg_hi:[0,1]
    v_pk_fma_f32 v[32:33], v[34:35], v[18:19], v[32:33] op_sel:[1,1,0] op_sel_hi:[0,1,1] neg_lo:[0,1,0] neg_hi:[0,1,0]
    v_pk_fma_f32 v[36:37], v[38:39], v[22:23], v[36:37] op_sel:[1,1,0] op_sel_hi:[0,1,1] neg_lo:[0,1,0] neg_hi:[0,1,0]
    v_pk_fma_f32 v[40:41], v[42:43], v[26:27], v[40:41] op_sel:[1,1,0] op_sel_hi:[0,1,1] neg_lo:[0,1,0] neg_hi:[0,1,0]
    v_pk_fma_f32 v[44:45], v[46:47], v[30:31], v[44:45] op_sel:[1,1,0] op_sel_hi:[0,1,1] neg_lo:[0,1,0] neg_hi:[0,1,0]
    v_cvt_pk_f16_f32 v88, v32, v33
    v_cvt_pk_f16_f32 v89, v36, v37
    v_cvt_pk_f16_f32 v90, v40, v41
    v_cvt_pk_f16_f32 v91, v44, v45
    v_pk_mul_f32 v[48:49], v[16:17], v[8:9]
    v_pk_mul_f32 v[52:53], v[20:21], v[8:9]
    v_pk_mul_f32 v[56:57], v[24:25], v[8:9]
    v_pk_mul_f32 v[60:61], v[28:29], v[8:9]
    v_fract_f32 v49, v49
    v_fract_f32 v53, v53
    v_fract_f32 v57, v57
    v_fract_f32 v61, v61
    v_exp_f32 v48, v48
    v_exp_f32 v52, v52
    v_exp_f32 v56, v56
    v_exp_f32 v60, v60
    v_cos_f32 v50, v49
    v_cos_f32 v54, v53
    v_cos_f32 v58, v57
    v_cos_f32 v62, v61
    v_sin_f32 v51, v49
    v_sin_f32 v55, v53
    v_sin_f32 v59, v57
    v_sin_f32 v63, v61
    v_pk_mul_f32 v[50:51], v[50:51], v[48:49] op_sel_hi:[1,0]
    v_pk_mul_f32 v[54:55], v[54:55], v[52:53] op_sel_hi:[1,0]
    v_pk_mul_f32 v[58:59], v[58:59], v[56:57] op_sel_hi:[1,0]
    v_pk_mul_f32 v[62:63], v[62:63], v[60:61] op_sel_hi:[1,0]
    v_cvt_pk_f16_f32 v64, v50, v51
    v_cvt_pk_f16_f32 v65, v54, v55
    v_cvt_pk_f16_f32 v66, v58, v59
    v_cvt_pk_f16_f32 v67, v62, v63
    s_nop 1
    v_mfma_f32_16x16x32_f16 v[96:99], v[64:67], v[88:91], v[96:99]
    v_pk_mul_f32 v[32:33], v[16:17], v[10:11]
    v_pk_mul_f32 v[36:37], v[20:21], v[10:11]
    v_pk_mul_f32 v[40:41], v[24:25], v[10:11]
    v_pk_mul_f32 v[44:45], v[28:29], v[10:11]
    v_fract_f32 v33, v33
    v_fract_f32 v37, v37
    v_fract_f32 v41, v41
    v_fract_f32 v45, v45
    v_exp_f32 v32, v32
    v_exp_f32 v36, v36
    v_exp_f32 v40, v40
    v_exp_f32 v44, v44
    v_cos_f32 v34, v33
    v_cos_f32 v38, v37
    v_cos_f32 v42, v41
    v_cos_f32 v46, v45
    v_sin_f32 v35, v33
    v_sin_f32 v39, v37
    v_sin_f32 v43, v41
    v_sin_f32 v47, v45
    v_pk_mul_f32 v[34:35], v[34:35], v[32:33] op_sel_hi:[1,0]
    v_pk_mul_f32 v[38:39], v[38:39], v[36:37] op_sel_hi:[1,0]
    v_pk_mul_f32 v[42:43], v[42:43], v[40:41] op_sel_hi:[1,0]
    v_pk_mul_f32 v[46:47], v[46:47], v[44:45] op_sel_hi:[1,0]
    v_cvt_pk_f16_f32 v68, v34, v35
    v_cvt_pk_f16_f32 v69, v38, v39
    v_cvt_pk_f16_f32 v70, v42, v43
    v_cvt_pk_f16_f32 v71, v46, v47
    s_nop 1
    v_mfma_f32_16x16x32_f16 v[100:103], v[68:71], v[88:91], v[100:103]
    v_pk_mul_f32 v[48:49], v[16:17], v[12:13]
    v_pk_mul_f32 v[52:53], v[20:21], v[12:13]
    v_pk_mul_f32 v[56:57], v[24:25], v[12:13]
    v_pk_mul_f32 v[60:61], v[28:29], v[12:13]
    v_fract_f32 v49, v49
    v_fract_f32 v53, v53
    v_fract_f32 v57, v57
    v_fract_f32 v61, v61
    v_exp_f32 v48, v48
    v_exp_f32 v52, v52
    v_exp_f32 v56, v56
    v_exp_f32 v60, v60
    v_cos_f32 v50, v49
    v_cos_f32 v54, v53
    v_cos_f32 v58, v57
    v_cos_f32 v62, v61
    v_sin_f32 v51, v49
    v_sin_f32 v55, v53
    v_sin_f32 v59, v57
    v_sin_f32 v63, v61
    v_pk_mul_f32 v[50:51], v[50:51], v[48:49] op_sel_hi:[1,0]
    v_pk_mul_f32 v[54:55], v[54:55], v[52:53] op_sel_hi:[1,0]
    v_pk_mul_f32 v[58:59], v[58:59], v[56:57] op_sel_hi:[1,0]
    v_pk_mul_f32 v[62:63], v[62:63], v[60:61] op_sel_hi:[1,0]
    v_cvt_pk_f16_f32 v72, v50, v51
    v_cvt_pk_f16_f32 v73, v54, v55
    v_cvt_pk_f16_f32 v74, v58, v59
    v_cvt_pk_f16_f32 v75, v62, v63
    s_nop 1
    v_mfma_f32_16x16x32_f16 v[104:107], v[72:75], v[88:91], v[104:107]
    s_add_u32 s21, s21, 1
    s_cmp_lt_u32 s21, 8
    s_cbranch_scc1 L_kg_loop
    s_mov_b32 s44, s38
    s_mov_b32 s45, s39
    s_mov_b32 s46, 0x400000
    s_and_b32 s23, s16, 31
    s_lshl_b32 s23, s23, 6
    s_lshr_b32 s24, s16, 5
    s_lshl_b32 s24, s24, 7
    s_lshl_b32 s20, s22, 5
    s_add_u32 s24, s24, s20
    v_lshrrev_b32 v2, 2, v1
    v_and_b32 v5, 3, v1
    v_add_u32 v2, s23, v2
    v_lshlrev_b32 v2, 11, v2
    v_lshlrev_b32 v5, 4, v5
    v_add_u32 v2, v2, v5
    s_lshl_b32 s20, s24, 1
    v_add_u32 v2, s20, v2
    s_mov_b32 s20, 32768
    s_mov_b32 s21, 65536
    s_mov_b32 s27, 98304
    buffer_load_dwordx4 v[112:115], v2, s[44:47], 0 offen
    buffer_load_dwordx4 v[116:119], v2, s[44:47], s20 offen
    buffer_load_dwordx4 v[120:123], v2, s[44:47], s21 offen
    buffer_load_dwordx4 v[124:127], v2, s[44:47], s27 offen
    s_mov_b32 s44, s36
    s_mov_b32 s45, s37
    s_mov_b32 s46, 0x200000
    s_lshl_b32 s20, s16, 13
    s_lshl_b32 s21, s22, 11
    s_add_u32 s20, s20, s21
    v_and_b32 v2, 15, v1
    v_lshlrev_b32 v2, 7, v2
    buffer_load_dword v221, v2, s[44:47], s20 offen
    v_lshlrev_b32 v6, 4, v4
    v_add_u32 v6, s26, v6
    ds_read_b128 v[16:19], v6 offset:6656
    ds_read_b128 v[20:23], v6 offset:6720
    ds_read_b128 v[24:27], v6 offset:6784
    s_add_u32 s3, s26, 2048
    v_lshlrev_b32 v5, 4, v3
    v_add_u32 v5, s3, v5
    v_mul_f32 v96, v111, v96
    v_mul_f32 v97, v111, v97
    v_mul_f32 v98, v111, v98
    v_mul_f32 v99, v111, v99
    v_mul_f32 v100, v111, v100
    v_mul_f32 v101, v111, v101
    v_mul_f32 v102, v111, v102
    v_mul_f32 v103, v111, v103
    v_mul_f32 v104, v111, v104
    v_mul_f32 v105, v111, v105
    v_mul_f32 v106, v111, v106
    v_mul_f32 v107, v111, v107
    s_waitcnt lgkmcnt(0)
    v_lshl_add_u32 v16, v16, 1, v5
    v_lshl_add_u32 v17, v17, 1, v5
    v_lshl_add_u32 v18, v18, 1, v5
    v_lshl_add_u32 v19, v19, 1, v5
    v_lshl_add_u32 v20, v20, 1, v5
    v_lshl_add_u32 v21, v21, 1, v5
    v_lshl_add_u32 v22, v22, 1, v5
    v_lshl_add_u32 v23, v23, 1, v5
    v_lshl_add_u32 v24, v24, 1, v5
    v_lshl_add_u32 v25, v25, 1, v5
    v_lshl_add_u32 v26, v26, 1, v5
    v_lshl_add_u32 v27, v27, 1, v5
    v_cvt_pk_bf16_f32 v32, v96, v97
    v_cvt_pk_bf16_f32 v34, v98, v99
    v_cvt_pk_bf16_f32 v36, v100, v101
    v_cvt_pk_bf16_f32 v38, v102, v103
    v_cvt_pk_bf16_f32 v40, v104, v105
    v_cvt_pk_bf16_f32 v42, v106, v107
    ds_write_b16 v16, v32
    ds_write_b16_d16_hi v17, v32
    ds_write_b16 v18, v34
    ds_write_b16_d16_hi v19, v34
    ds_write_b16 v20, v36
    ds_write_b16_d16_hi v21, v36
    ds_write_b16 v22, v38
    ds_write_b16_d16_hi v23, v38
    ds_write_b16 v24, v40
    ds_write_b16_d16_hi v25, v40
    ds_write_b16 v26, v42
    ds_write_b16_d16_hi v27, v42
    v_lshlrev_b32 v2, 3, v1
    v_cvt_f32_u32 v2, v2
    v_lshlrev_b32 v3, 4, v1
    s_lshl_b32 s28, s25, 12
    s_add_u32 s28, s28, 12582912
    s_mov_b32 s30, 0xffff0000
    v_add_f32 v128, 0.0, v2
    v_add_f32 v129, 1.0, v2
    v_add_f32 v132, 2.0, v2
    v_add_f32 v133, 3.0, v2
    v_add_f32 v136, 4.0, v2
    v_add_f32 v137, 5.0, v2
    v_add_f32 v140, 6.0, v2
    v_add_f32 v141, 7.0, v2
    v_cvt_pk_bf16_f32 v128, v128, v129
    v_cvt_pk_bf16_f32 v132, v132, v133
    v_cvt_pk_bf16_f32 v136, v136, v137
    v_cvt_pk_bf16_f32 v140, v140, v141
    v_and_b32 v129, 0xffff0000, v128
    v_lshlrev_b32 v128, 16, v128
    v_and_b32 v133, 0xffff0000, v132
    v_lshlrev_b32 v132, 16, v132
    v_and_b32 v137, 0xffff0000, v136
    v_lshlrev_b32 v136, 16, v136
    v_and_b32 v141, 0xffff0000, v140
    v_lshlrev_b32 v140, 16, v140
    v_cvt_u32_f32 v128, v128
    v_cvt_u32_f32 v129, v129
    v_cvt_u32_f32 v132, v132
    v_cvt_u32_f32 v133, v133
    v_cvt_u32_f32 v136, v136
    v_cvt_u32_f32 v137, v137
    v_cvt_u32_f32 v140, v140
    v_cvt_u32_f32 v141, v141
    v_lshl_add_u32 v128, v128, 1, s3
    v_lshl_add_u32 v129, v129, 1, s3
    v_lshl_add_u32 v132, v132, 1, s3
    v_lshl_add_u32 v133, v133, 1, s3
    v_lshl_add_u32 v136, v136, 1, s3
    v_lshl_add_u32 v137, v137, 1, s3
    v_lshl_add_u32 v140, v140, 1, s3
    v_lshl_add_u32 v141, v141, 1, s3
    v_add_f32 v144, 512.0, v2
    v_add_f32 v145, 513.0, v2
    v_add_f32 v148, 514.0, v2
    v_add_f32 v149, 515.0, v2
    v_add_f32 v152, 516.0, v2
    v_add_f32 v153, 517.0, v2
    v_add_f32 v156, 518.0, v2
    v_add_f32 v157, 519.0, v2
    v_cvt_pk_bf16_f32 v144, v144, v145
    v_cvt_pk_bf16_f32 v148, v148, v149
    v_cvt_pk_bf16_f32 v152, v152, v153
    v_cvt_pk_bf16_f32 v156, v156, v157
    v_and_b32 v145, 0xffff0000, v144
    v_lshlrev_b32 v144, 16, v144
    v_and_b32 v149, 0xffff0000, v148
    v_lshlrev_b32 v148, 16, v148
    v_and_b32 v153, 0xffff0000, v152
    v_lshlrev_b32 v152, 16, v152
    v_and_b32 v157, 0xffff0000, v156
    v_lshlrev_b32 v156, 16, v156
    v_cvt_u32_f32 v144, v144
    v_cvt_u32_f32 v145, v145
    v_cvt_u32_f32 v148, v148
    v_cvt_u32_f32 v149, v149
    v_cvt_u32_f32 v152, v152
    v_cvt_u32_f32 v153, v153
    v_cvt_u32_f32 v156, v156
    v_cvt_u32_f32 v157, v157
    v_lshl_add_u32 v144, v144, 1, s3
    v_lshl_add_u32 v145, v145, 1, s3
    v_lshl_add_u32 v148, v148, 1, s3
    v_lshl_add_u32 v149, v149, 1, s3
    v_lshl_add_u32 v152, v152, 1, s3
    v_lshl_add_u32 v153, v153, 1, s3
    v_lshl_add_u32 v156, v156, 1, s3
    v_lshl_add_u32 v157, v157, 1, s3
    v_add_f32 v160, 1024.0, v2
    v_add_f32 v161, 1025.0, v2
    v_add_f32 v164, 1026.0, v2
    v_add_f32 v165, 1027.0, v2
    v_add_f32 v168, 1028.0, v2
    v_add_f32 v169, 1029.0, v2
    v_add_f32 v172, 1030.0, v2
    v_add_f32 v173, 1031.0, v2
    v_cvt_pk_bf16_f32 v160, v160, v161
    v_cvt_pk_bf16_f32 v164, v164, v165
    v_cvt_pk_bf16_f32 v168, v168, v169
    v_cvt_pk_bf16_f32 v172, v172, v173
    v_and_b32 v161, 0xffff0000, v160
    v_lshlrev_b32 v160, 16, v160
    v_and_b32 v165, 0xffff0000, v164
    v_lshlrev_b32 v164, 16, v164
    v_and_b32 v169, 0xffff0000, v168
    v_lshlrev_b32 v168, 16, v168
    v_and_b32 v173, 0xffff0000, v172
    v_lshlrev_b32 v172, 16, v172
    v_cvt_u32_f32 v160, v160
    v_cvt_u32_f32 v161, v161
    v_cvt_u32_f32 v164, v164
    v_cvt_u32_f32 v165, v165
    v_cvt_u32_f32 v168, v168
    v_cvt_u32_f32 v169, v169
    v_cvt_u32_f32 v172, v172
    v_cvt_u32_f32 v173, v173
    v_lshl_add_u32 v160, v160, 1, s3
    v_lshl_add_u32 v161, v161, 1, s3
    v_lshl_add_u32 v164, v164, 1, s3
    v_lshl_add_u32 v165, v165, 1, s3
    v_lshl_add_u32 v168, v168, 1, s3
    v_lshl_add_u32 v169, v169, 1, s3
    v_lshl_add_u32 v172, v172, 1, s3
    v_lshl_add_u32 v173, v173, 1, s3
    v_add_f32 v176, 1536.0, v2
    v_add_f32 v177, 1537.0, v2
    v_add_f32 v180, 1538.0, v2
    v_add_f32 v181, 1539.0, v2
    v_add_f32 v184, 1540.0, v2
    v_add_f32 v185, 1541.0, v2
    v_add_f32 v188, 1542.0, v2
    v_add_f32 v189, 1543.0, v2
    v_cvt_pk_bf16_f32 v176, v176, v177
    v_cvt_pk_bf16_f32 v180, v180, v181
    v_cvt_pk_bf16_f32 v184, v184, v185
    v_cvt_pk_bf16_f32 v188, v188, v189
    v_and_b32 v177, 0xffff0000, v176
    v_lshlrev_b32 v176, 16, v176
    v_and_b32 v181, 0xffff0000, v180
    v_lshlrev_b32 v180, 16, v180
    v_and_b32 v185, 0xffff0000, v184
    v_lshlrev_b32 v184, 16, v184
    v_and_b32 v189, 0xffff0000, v188
    v_lshlrev_b32 v188, 16, v188
    v_cvt_u32_f32 v176, v176
    v_cvt_u32_f32 v177, v177
    v_cvt_u32_f32 v180, v180
    v_cvt_u32_f32 v181, v181
    v_cvt_u32_f32 v184, v184
    v_cvt_u32_f32 v185, v185
    v_cvt_u32_f32 v188, v188
    v_cvt_u32_f32 v189, v189
    v_lshl_add_u32 v176, v176, 1, s3
    v_lshl_add_u32 v177, v177, 1, s3
    v_lshl_add_u32 v180, v180, 1, s3
    v_lshl_add_u32 v181, v181, 1, s3
    v_lshl_add_u32 v184, v184, 1, s3
    v_lshl_add_u32 v185, v185, 1, s3
    v_lshl_add_u32 v188, v188, 1, s3
    v_lshl_add_u32 v189, v189, 1, s3
    s_waitcnt lgkmcnt(0)
    ds_read_u16 v32, v128
    ds_read_u16_d16_hi v48, v129
    ds_read_u16 v33, v132
    ds_read_u16_d16_hi v49, v133
    ds_read_u16 v34, v136
    ds_read_u16_d16_hi v50, v137
    ds_read_u16 v35, v140
    ds_read_u16_d16_hi v51, v141
    ds_read_u16 v36, v144
    ds_read_u16_d16_hi v52, v145
    ds_read_u16 v37, v148
    ds_read_u16_d16_hi v53, v149
    ds_read_u16 v38, v152
    ds_read_u16_d16_hi v54, v153
    ds_read_u16 v39, v156
    ds_read_u16_d16_hi v55, v157
    ds_read_u16 v40, v160
    ds_read_u16_d16_hi v56, v161
    ds_read_u16 v41, v164
    ds_read_u16_d16_hi v57, v165
    ds_read_u16 v42, v168
    ds_read_u16_d16_hi v58, v169
    ds_read_u16 v43, v172
    ds_read_u16_d16_hi v59, v173
    ds_read_u16 v44, v176
    ds_read_u16_d16_hi v60, v177
    ds_read_u16 v45, v180
    ds_read_u16_d16_hi v61, v181
    ds_read_u16 v46, v184
    ds_read_u16_d16_hi v62, v185
    ds_read_u16 v47, v188
    ds_read_u16_d16_hi v63, v189
    s_waitcnt lgkmcnt(0)
    v_and_or_b32 v32, v48, s30, v32
    v_and_or_b32 v33, v49, s30, v33
    v_and_or_b32 v34, v50, s30, v34
    v_and_or_b32 v35, v51, s30, v35
    v_and_or_b32 v36, v52, s30, v36
    v_and_or_b32 v37, v53, s30, v37
    v_and_or_b32 v38, v54, s30, v38
    v_and_or_b32 v39, v55, s30, v39
    v_and_or_b32 v40, v56, s30, v40
    v_and_or_b32 v41, v57, s30, v41
    v_and_or_b32 v42, v58, s30, v42
    v_and_or_b32 v43, v59, s30, v43
    v_and_or_b32 v44, v60, s30, v44
    v_and_or_b32 v45, v61, s30, v45
    v_and_or_b32 v46, v62, s30, v46
    v_and_or_b32 v47, v63, s30, v47
    buffer_store_dwordx4 v[32:35], v3, s[12:15], s28 offen offset:0
    buffer_store_dwordx4 v[36:39], v3, s[12:15], s28 offen offset:1024
    buffer_store_dwordx4 v[40:43], v3, s[12:15], s28 offen offset:2048
    buffer_store_dwordx4 v[44:47], v3, s[12:15], s28 offen offset:3072
    v_lshrrev_b32 v2, 2, v1
    v_and_b32 v3, 3, v1
    v_mul_u32_u24 v6, 80, v2
    v_lshlrev_b32 v3, 4, v3
    v_add3_u32 v6, v6, v3, s26
    s_waitcnt vmcnt(4)
    ds_write_b128 v6, v[112:115]
    ds_write_b128 v6, v[116:119] offset:1280
    ds_write_b128 v6, v[120:123] offset:2560
    ds_write_b128 v6, v[124:127] offset:3840
    v_and_b32 v2, 15, v1
    v_lshrrev_b32 v3, 2, v2
    v_and_b32 v4, 3, v2
    v_lshrrev_b32 v5, 4, v1
    v_lshlrev_b32 v6, 3, v5
    v_add_u32 v6, v6, v3
    v_sub_u32 v6, 27, v6
    v_mul_u32_u24 v6, 80, v6
    v_lshlrev_b32 v4, 3, v4
    v_add3_u32 v6, v6, v4, s26
    s_waitcnt lgkmcnt(0)
    ds_read_b64_tr_b16 v[16:17], v6 offset:2880
    ds_read_b64_tr_b16 v[18:19], v6 offset:2560
    ds_read_b64_tr_b16 v[20:21], v6 offset:320
    ds_read_b64_tr_b16 v[22:23], v6 offset:0
    ds_read_b64_tr_b16 v[24:25], v6 offset:2912
    ds_read_b64_tr_b16 v[26:27], v6 offset:2592
    ds_read_b64_tr_b16 v[28:29], v6 offset:352
    ds_read_b64_tr_b16 v[30:31], v6 offset:32
    v_add_u32 v2, s24, v2
    v_lshlrev_b32 v2, 12, v2
    v_lshlrev_b32 v5, 4, v5
    v_add_u32 v2, v2, v5
    s_sub_u32 s20, 1984, s23
    s_lshl_b32 s20, s20, 1
    s_add_u32 s20, s20, 8388608
    s_add_u32 s21, s20, 65536
    s_waitcnt lgkmcnt(0)
    buffer_store_dwordx4 v[16:19], v2, s[12:15], s20 offen
    buffer_store_dwordx4 v[20:23], v2, s[12:15], s20 offen offset:64
    buffer_store_dwordx4 v[24:27], v2, s[12:15], s21 offen
    buffer_store_dwordx4 v[28:31], v2, s[12:15], s21 offen offset:64
    s_endpgm
L_k1_end:
    s_endpgm

.text
.globl k2_kernel
.p2align 8
.type k2_kernel,@function
k2_kernel:
    s_cmp_ge_u32 s2, 256
    s_cbranch_scc1 L_k2_end
    s_load_dwordx2 s[36:37], s[0:1], 96
    s_load_dwordx2 s[38:39], s[0:1], 72
    s_load_dwordx2 s[40:41], s[0:1], 16
    s_load_dwordx2 s[44:45], s[0:1], 80
    v_and_b32 v1, 63, v0
    v_lshrrev_b32 v2, 6, v0
    s_nop 0
    v_readfirstlane_b32 s22, v2
    s_and_b32 s16, s2, 7
    s_lshr_b32 s17, s2, 3
    s_and_b32 s18, s16, 3
    s_lshl_b32 s18, s18, 2
    s_and_b32 s19, s17, 3
    s_add_u32 s18, s18, s19
    s_lshr_b32 s19, s16, 2
    s_lshl_b32 s19, s19, 3
    s_lshr_b32 s20, s17, 2
    s_add_u32 s19, s19, s20
    s_lshl_b32 s23, s2, 2
    s_add_u32 s23, s23, s22
    s_mul_i32 s26, s22, 21824
    s_lshl_b32 s24, s23, 12
    v_lshlrev_b32 v2, 4, v1
    s_waitcnt lgkmcnt(0)
    s_mov_b32 s12, s36
    s_mov_b32 s13, s37
    s_mov_b32 s14, 0x10000000
    s_mov_b32 s15, 0x00020000
    s_add_u32 s4, s36, s24
    s_addc_u32 s5, s37, 0
    s_add_u32 s4, s4, 8388608
    s_addc_u32 s5, s5, 0
    s_mov_b32 s6, 4096
    s_mov_b32 s7, 0x00020000
    buffer_load_dwordx4 v[48:51], v2, s[4:7], 0 offen offset:0
    buffer_load_dwordx4 v[52:55], v2, s[4:7], 0 offen offset:4
    buffer_load_dwordx2 v[56:57], v2, s[4:7], 0 offen offset:16
    buffer_load_dwordx4 v[60:63], v2, s[4:7], 0 offen offset:1024
    buffer_load_dwordx4 v[64:67], v2, s[4:7], 0 offen offset:1028
    buffer_load_dwordx2 v[68:69], v2, s[4:7], 0 offen offset:1040
    buffer_load_dwordx4 v[72:75], v2, s[4:7], 0 offen offset:2048
    buffer_load_dwordx4 v[76:79], v2, s[4:7], 0 offen offset:2052
    buffer_load_dwordx2 v[80:81], v2, s[4:7], 0 offen offset:2064
    buffer_load_dwordx4 v[84:87], v2, s[4:7], 0 offen offset:3072
    buffer_load_dwordx4 v[88:91], v2, s[4:7], 0 offen offset:3076
    buffer_load_dwordx2 v[92:93], v2, s[4:7], 0 offen offset:3088
    s_and_b32 s20, s2, 31
    s_lshr_b32 s21, s2, 5
    s_lshl_b32 s25, s20, 16
    s_lshl_b32 s27, s22, 14
    s_add_u32 s25, s25, s27
    s_add_u32 s25, s25, 4194304
    s_add_u32 s27, s27, 87296
    s_add_u32 m0, s27, 0
    s_add_u32 s29, s25, 0
    buffer_load_dwordx4 v2, s[12:15], s29 offen lds
    s_add_u32 m0, s27, 1024
    s_add_u32 s29, s25, 1024
    buffer_load_dwordx4 v2, s[12:15], s29 offen lds
    s_add_u32 m0, s27, 2048
    s_add_u32 s29, s25, 2048
    buffer_load_dwordx4 v2, s[12:15], s29 offen lds
    s_add_u32 m0, s27, 3072
    s_add_u32 s29, s25, 3072
    buffer_load_dwordx4 v2, s[12:15], s29 offen lds
    s_add_u32 m0, s27, 4096
    s_add_u32 s29, s25, 4096
    buffer_load_dwordx4 v2, s[12:15], s29 offen lds
    s_add_u32 m0, s27, 5120
    s_add_u32 s29, s25, 5120
    buffer_load_dwordx4 v2, s[12:15], s29 offen lds
    s_add_u32 m0, s27, 6144
    s_add_u32 s29, s25, 6144
    buffer_load_dwordx4 v2, s[12:15], s29 offen lds
    s_add_u32 m0, s27, 7168
    s_add_u32 s29, s25, 7168
    buffer_load_dwordx4 v2, s[12:15], s29 offen lds
    s_add_u32 m0, s27, 8192
    s_add_u32 s29, s25, 8192
    buffer_load_dwordx4 v2, s[12:15], s29 offen lds
    s_add_u32 m0, s27, 9216
    s_add_u32 s29, s25, 9216
    buffer_load_dwordx4 v2, s[12:15], s29 offen lds
    s_add_u32 m0, s27, 10240
    s_add_u32 s29, s25, 10240
    buffer_load_dwordx4 v2, s[12:15], s29 offen lds
    s_add_u32 m0, s27, 11264
    s_add_u32 s29, s25, 11264
    buffer_load_dwordx4 v2, s[12:15], s29 offen lds
    s_add_u32 m0, s27, 12288
    s_add_u32 s29, s25, 12288
    buffer_load_dwordx4 v2, s[12:15], s29 offen lds
    s_add_u32 m0, s27, 13312
    s_add_u32 s29, s25, 13312
    buffer_load_dwordx4 v2, s[12:15], s29 offen lds
    s_add_u32 m0, s27, 14336
    s_add_u32 s29, s25, 14336
    buffer_load_dwordx4 v2, s[12:15], s29 offen lds
    s_add_u32 m0, s27, 15360
    s_add_u32 s29, s25, 15360
    buffer_load_dwordx4 v2, s[12:15], s29 offen lds
    s_and_b32 s27, s22, 1
    s_lshl_b32 s27, s27, 10
    s_lshl_b32 s25, s20, 11
    s_add_u32 s25, s25, s27
    s_add_u32 s25, s25, 6291456
    s_add_u32 m0, s27, 152832
    s_nop 0
    buffer_load_dwordx4 v2, s[12:15], s25 offen lds
    s_lshl_b32 s27, s21, 3
    s_lshl_b32 s25, s22, 1
    s_add_u32 s27, s27, s25
    s_lshl_b32 s27, s27, 5
    s_add_u32 s27, s27, s20
    s_lshl_b32 s27, s27, 11
    s_add_u32 s28, s27, 0
    s_add_u32 s31, s27, 16777216
    s_add_u32 s29, s28, 65536
    buffer_load_dwordx4 v[176:179], v2, s[12:15], s28 offen
    buffer_load_dwordx4 v[180:183], v2, s[12:15], s28 offen offset:1024
    buffer_load_dwordx4 v[184:187], v2, s[12:15], s29 offen
    buffer_load_dwordx4 v[188:191], v2, s[12:15], s29 offen offset:1024
    s_add_u32 s27, s24, 12582912
    s_add_u32 s28, s26, 17664
    s_add_u32 m0, s28, 0
    s_add_u32 s29, s27, 0
    buffer_load_dwordx4 v2, s[12:15], s29 offen lds
    s_add_u32 m0, s28, 1024
    s_add_u32 s29, s27, 1024
    buffer_load_dwordx4 v2, s[12:15], s29 offen lds
    s_add_u32 m0, s28, 2048
    s_add_u32 s29, s27, 2048
    buffer_load_dwordx4 v2, s[12:15], s29 offen lds
    s_add_u32 m0, s28, 3072
    s_add_u32 s29, s27, 3072
    buffer_load_dwordx4 v2, s[12:15], s29 offen lds
    s_mov_b32 s8, s38
    s_mov_b32 s9, s39
    s_mov_b32 s10, 2048
    s_mov_b32 s11, 0x00020000
    s_lshl_b32 s25, s23, 1
    v_mov_b32 v3, s25
    buffer_load_ushort v14, v3, s[8:11], 0 offen
    s_add_u32 s48, s36, 27262976
    s_addc_u32 s49, s37, 0
    s_mov_b32 s50, 4096
    s_mov_b32 s51, 0x00020000
    s_mov_b32 s52, s40
    s_mov_b32 s53, s41
    s_mov_b32 s54, 0x200000
    s_mov_b32 s55, 0x00020000
    s_mov_b32 s56, s44
    s_mov_b32 s57, s45
    s_mov_b32 s58, 0x800000
    s_mov_b32 s59, 0x00020000
    v_mov_b32 v4, 0
    v_mov_b32 v5, 0
    v_mov_b32 v6, 0
    v_mov_b32 v7, 0
    v_lshlrev_b32 v3, 3, v1
    v_add_u32 v3, s26, v3
    ds_write_b64 v3, v[4:5] offset:17152
    v_and_b32 v8, 7, v1
    v_lshlrev_b32 v8, 3, v8
    v_add_u32 v8, s26, v8
    ds_write_b64 v8, v[4:5] offset:21760
    v_and_b32 v3, 31, v1
    v_lshrrev_b32 v8, 3, v3
    v_and_b32 v3, 7, v3
    v_add_u32 v9, 256, v3
    v_cmp_gt_u32 vcc, 2, v3
    s_nop 1
    v_cndmask_b32 v3, v9, v3, vcc
    v_lshlrev_b32 v3, 4, v3
    v_mul_u32_u24 v8, 4288, v8
    v_add3_u32 v3, v3, v8, s26
    ds_write_b128 v3, v[4:7]
    v_add_u32 v3, s26, v2
    s_waitcnt vmcnt(35)
    v_alignbyte_b32 v100, v49, v48, 2
    v_alignbyte_b32 v101, v50, v49, 2
    v_alignbyte_b32 v102, v51, v50, 2
    v_alignbyte_b32 v103, v56, v51, 2
    v_alignbyte_b32 v104, v50, v49, 2
    v_alignbyte_b32 v105, v51, v50, 2
    v_alignbyte_b32 v106, v56, v51, 2
    v_alignbyte_b32 v107, v57, v56, 2
    ds_write_b128 v3, v[48:51] offset:32
    ds_write_b128 v3, v[100:103] offset:4320
    ds_write_b128 v3, v[52:55] offset:8608
    ds_write_b128 v3, v[104:107] offset:12896
    s_waitcnt vmcnt(32)
    v_alignbyte_b32 v108, v61, v60, 2
    v_alignbyte_b32 v109, v62, v61, 2
    v_alignbyte_b32 v110, v63, v62, 2
    v_alignbyte_b32 v111, v68, v63, 2
    v_alignbyte_b32 v112, v62, v61, 2
    v_alignbyte_b32 v113, v63, v62, 2
    v_alignbyte_b32 v114, v68, v63, 2
    v_alignbyte_b32 v115, v69, v68, 2
    ds_write_b128 v3, v[60:63] offset:1056
    ds_write_b128 v3, v[108:111] offset:5344
    ds_write_b128 v3, v[64:67] offset:9632
    ds_write_b128 v3, v[112:115] offset:13920
    s_waitcnt vmcnt(29)
    v_alignbyte_b32 v100, v73, v72, 2
    v_alignbyte_b32 v101, v74, v73, 2
    v_alignbyte_b32 v102, v75, v74, 2
    v_alignbyte_b32 v103, v80, v75, 2
    v_alignbyte_b32 v104, v74, v73, 2
    v_alignbyte_b32 v105, v75, v74, 2
    v_alignbyte_b32 v106, v80, v75, 2
    v_alignbyte_b32 v107, v81, v80, 2
    ds_write_b128 v3, v[72:75] offset:2080
    ds_write_b128 v3, v[100:103] offset:6368
    ds_write_b128 v3, v[76:79] offset:10656
    ds_write_b128 v3, v[104:107] offset:14944
    s_waitcnt vmcnt(26)
    v_alignbyte_b32 v108, v85, v84, 2
    v_alignbyte_b32 v109, v86, v85, 2
    v_alignbyte_b32 v110, v87, v86, 2
    v_alignbyte_b32 v111, v92, v87, 2
    v_alignbyte_b32 v112, v86, v85, 2
    v_alignbyte_b32 v113, v87, v86, 2
    v_alignbyte_b32 v114, v92, v87, 2
    v_alignbyte_b32 v115, v93, v92, 2
    ds_write_b128 v3, v[84:87] offset:3104
    ds_write_b128 v3, v[108:111] offset:7392
    ds_write_b128 v3, v[88:91] offset:11680
    ds_write_b128 v3, v[112:115] offset:15968
    s_lshl_b32 s27, s22, 10
    s_add_u32 s27, s27, 87296
    v_add_u32 v3, s27, v2
    v_lshlrev_b32 v4, 2, v1
    v_add_u32 v4, 152832, v4
    s_waitcnt vmcnt(9)
    s_barrier
    ds_read_b32 v112, v4 offset:0
    ds_read_b32 v113, v4 offset:256
    ds_read_b32 v114, v4 offset:512
    ds_read_b32 v115, v4 offset:768
    ds_read_b32 v116, v4 offset:1024
    ds_read_b32 v117, v4 offset:1280
    ds_read_b32 v118, v4 offset:1536
    ds_read_b32 v119, v4 offset:1792
    ds_read_b128 v[48:51], v3 offset:0
    ds_read_b128 v[52:55], v3 offset:4096
    ds_read_b128 v[56:59], v3 offset:8192
    ds_read_b128 v[60:63], v3 offset:12288
    ds_read_b128 v[64:67], v3 offset:16384
    ds_read_b128 v[68:71], v3 offset:20480
    ds_read_b128 v[72:75], v3 offset:24576
    ds_read_b128 v[76:79], v3 offset:28672
    ds_read_b128 v[80:83], v3 offset:32768
    ds_read_b128 v[84:87], v3 offset:36864
    ds_read_b128 v[88:91], v3 offset:40960
    ds_read_b128 v[92:95], v3 offset:45056
    ds_read_b128 v[96:99], v3 offset:49152
    ds_read_b128 v[100:103], v3 offset:53248
    ds_read_b128 v[104:107], v3 offset:57344
    ds_read_b128 v[108:111], v3 offset:61440
    s_waitcnt lgkmcnt(15)
    v_add_f32 v112, v112, v113
    v_add_f32 v114, v114, v115
    v_add_f32 v116, v116, v117
    v_add_f32 v118, v118, v119
    v_add_f32 v112, v112, v114
    v_add_f32 v116, v116, v118
    v_add_f32 v112, v112, v116
    v_mov_b32 v113, v112
    s_nop 1
    v_permlane32_swap_b32 v112, v113
    s_nop 1
    v_add_f32 v112, v112, v113
    s_lshl_b32 s27, s22, 7
    s_add_u32 s27, s27, 156928
    v_and_b32 v5, 31, v1
    v_lshlrev_b32 v5, 2, v5
    v_add_u32 v5, s27, v5
    ds_write_b32 v5, v112
    v_lshrrev_b32 v5, 5, v1
    v_lshlrev_b32 v5, 6, v5
    v_add_u32 v5, s27, v5
    s_waitcnt lgkmcnt(0)
    ds_read_b128 v[120:123], v5
    ds_read_b128 v[124:127], v5 offset:16
    ds_read_b128 v[128:131], v5 offset:32
    ds_read_b128 v[132:135], v5 offset:48
    v_pk_add_f32 v[48:49], v[48:49], v[52:53]
    v_pk_add_f32 v[50:51], v[50:51], v[54:55]
    v_pk_add_f32 v[56:57], v[56:57], v[60:61]
    v_pk_add_f32 v[58:59], v[58:59], v[62:63]
    v_pk_add_f32 v[64:65], v[64:65], v[68:69]
    v_pk_add_f32 v[66:67], v[66:67], v[70:71]
    v_pk_add_f32 v[72:73], v[72:73], v[76:77]
    v_pk_add_f32 v[74:75], v[74:75], v[78:79]
    v_pk_add_f32 v[80:81], v[80:81], v[84:85]
    v_pk_add_f32 v[82:83], v[82:83], v[86:87]
    v_pk_add_f32 v[88:89], v[88:89], v[92:93]
    v_pk_add_f32 v[90:91], v[90:91], v[94:95]
    v_pk_add_f32 v[96:97], v[96:97], v[100:101]
    v_pk_add_f32 v[98:99], v[98:99], v[102:103]
    v_pk_add_f32 v[104:105], v[104:105], v[108:109]
    v_pk_add_f32 v[106:107], v[106:107], v[110:111]
    v_pk_add_f32 v[48:49], v[48:49], v[56:57]
    v_pk_add_f32 v[50:51], v[50:51], v[58:59]
    v_pk_add_f32 v[64:65], v[64:65], v[72:73]
    v_pk_add_f32 v[66:67], v[66:67], v[74:75]
    v_pk_add_f32 v[80:81], v[80:81], v[88:89]
    v_pk_add_f32 v[82:83], v[82:83], v[90:91]
    v_pk_add_f32 v[96:97], v[96:97], v[104:105]
    v_pk_add_f32 v[98:99], v[98:99], v[106:107]
    v_pk_add_f32 v[48:49], v[48:49], v[64:65]
    v_pk_add_f32 v[50:51], v[50:51], v[66:67]
    v_pk_add_f32 v[80:81], v[80:81], v[96:97]
    v_pk_add_f32 v[82:83], v[82:83], v[98:99]
    v_pk_add_f32 v[48:49], v[48:49], v[80:81]
    v_pk_add_f32 v[50:51], v[50:51], v[82:83]
    v_cvt_pk_bf16_f32 v52, v48, v49
    v_cvt_pk_bf16_f32 v53, v50, v51
    v_lshlrev_b32 v6, 5, v1
    v_add_u32 v6, 154880, v6
    s_lshl_b32 s27, s22, 3
    v_add_u32 v7, s27, v6
    ds_write_b64 v7, v[52:53]
    s_waitcnt lgkmcnt(0)
    s_barrier
    ds_read_b128 v[96:99], v6
    ds_read_b128 v[100:103], v6 offset:16
    v_cvt_pk_bf16_f32 v104, v120, v121
    v_cvt_pk_bf16_f32 v105, v122, v123
    v_cvt_pk_bf16_f32 v106, v124, v125
    v_cvt_pk_bf16_f32 v107, v126, v127
    v_cvt_pk_bf16_f32 v108, v128, v129
    v_cvt_pk_bf16_f32 v109, v130, v131
    v_cvt_pk_bf16_f32 v110, v132, v133
    v_cvt_pk_bf16_f32 v111, v134, v135
    s_mov_b32 s30, 0x358637bd
    s_waitcnt vmcnt(5) lgkmcnt(0)
    v_mfma_f32_32x32x16_bf16 v[32:47], v[104:107], v[176:179], 0
    v_mfma_f32_32x32x16_bf16 v[16:31], v[96:99], v[176:179], 0
    v_mfma_f32_32x32x16_bf16 v[32:47], v[108:111], v[180:183], v[32:47]
    v_mfma_f32_32x32x16_bf16 v[16:31], v[100:103], v[180:183], v[16:31]
    v_mfma_f32_32x32x16_bf16 v[64:79], v[104:107], v[184:187], 0
    v_mfma_f32_32x32x16_bf16 v[48:63], v[96:99], v[184:187], 0
    v_mfma_f32_32x32x16_bf16 v[64:79], v[108:111], v[188:191], v[64:79]
    v_mfma_f32_32x32x16_bf16 v[48:63], v[100:103], v[188:191], v[48:63]
    v_lshrrev_b32 v13, 3, v1
    v_lshlrev_b32 v13, 11, v13
    s_lshl_b32 s3, s19, 7
    v_add_u32 v13, s3, v13
    v_and_b32 v8, 7, v1
    v_lshrrev_b32 v9, 4, v1
    v_and_b32 v9, 1, v9
    v_lshlrev_b32 v9, 2, v9
    v_xor_b32 v8, v8, v9
    v_lshlrev_b32 v8, 4, v8
    v_add_u32 v13, v13, v8
    v_cvt_pk_bf16_f32 v4, v32, v32
    v_lshlrev_b32 v4, 16, v4
    v_add_f32 v4, s30, v4
    v_cvt_pk_bf16_f32 v4, v4, v4
    v_lshlrev_b32 v4, 16, v4
    v_rcp_f32 v4, v4
    s_nop 0
    v_pk_mul_f32 v[16:17], v[16:17], v[4:5] op_sel_hi:[1,0]
    v_pk_mul_f32 v[18:19], v[18:19], v[4:5] op_sel_hi:[1,0]
    v_pk_mul_f32 v[20:21], v[20:21], v[4:5] op_sel_hi:[1,0]
    v_pk_mul_f32 v[22:23], v[22:23], v[4:5] op_sel_hi:[1,0]
    v_pk_mul_f32 v[24:25], v[24:25], v[4:5] op_sel_hi:[1,0]
    v_pk_mul_f32 v[26:27], v[26:27], v[4:5] op_sel_hi:[1,0]
    v_pk_mul_f32 v[28:29], v[28:29], v[4:5] op_sel_hi:[1,0]
    v_pk_mul_f32 v[30:31], v[30:31], v[4:5] op_sel_hi:[1,0]
    v_cvt_pk_bf16_f32 v176, v16, v17
    v_cvt_pk_bf16_f32 v177, v18, v19
    v_cvt_pk_bf16_f32 v178, v20, v21
    v_cvt_pk_bf16_f32 v179, v22, v23
    v_cvt_pk_bf16_f32 v180, v24, v25
    v_cvt_pk_bf16_f32 v181, v26, v27
    v_cvt_pk_bf16_f32 v182, v28, v29
    v_cvt_pk_bf16_f32 v183, v30, v31
    buffer_store_dwordx4 v[176:179], v2, s[12:15], s31 offen sc1
    buffer_store_dwordx4 v[180:183], v2, s[12:15], s31 offen offset:1024 sc1
    s_add_u32 s31, s31, 65536
    v_cvt_pk_bf16_f32 v4, v64, v64
    v_lshlrev_b32 v4, 16, v4
    v_add_f32 v4, s30, v4
    v_cvt_pk_bf16_f32 v4, v4, v4
    v_lshlrev_b32 v4, 16, v4
    v_rcp_f32 v4, v4
    s_nop 0
    v_pk_mul_f32 v[48:49], v[48:49], v[4:5] op_sel_hi:[1,0]
    v_pk_mul_f32 v[50:51], v[50:51], v[4:5] op_sel_hi:[1,0]
    v_pk_mul_f32 v[52:53], v[52:53], v[4:5] op_sel_hi:[1,0]
    v_pk_mul_f32 v[54:55], v[54:55], v[4:5] op_sel_hi:[1,0]
    v_pk_mul_f32 v[56:57], v[56:57], v[4:5] op_sel_hi:[1,0]
    v_pk_mul_f32 v[58:59], v[58:59], v[4:5] op_sel_hi:[1,0]
    v_pk_mul_f32 v[60:61], v[60:61], v[4:5] op_sel_hi:[1,0]
    v_pk_mul_f32 v[62:63], v[62:63], v[4:5] op_sel_hi:[1,0]
    v_cvt_pk_bf16_f32 v184, v48, v49
    v_cvt_pk_bf16_f32 v185, v50, v51
    v_cvt_pk_bf16_f32 v186, v52, v53
    v_cvt_pk_bf16_f32 v187, v54, v55
    v_cvt_pk_bf16_f32 v188, v56, v57
    v_cvt_pk_bf16_f32 v189, v58, v59
    v_cvt_pk_bf16_f32 v190, v60, v61
    v_cvt_pk_bf16_f32 v191, v62, v63
    buffer_store_dwordx4 v[184:187], v2, s[12:15], s31 offen sc1
    buffer_store_dwordx4 v[188:191], v2, s[12:15], s31 offen offset:1024 sc1
    s_add_u32 s31, s31, 65536
    s_lshl_b32 s27, s22, 14
    s_add_u32 s27, s27, 87296
    s_lshl_b32 s28, s22, 18
    v_and_b32 v4, 15, v1
    v_lshrrev_b32 v5, 4, v1
    v_sub_u32 v6, 3, v4
    v_and_b32 v6, 3, v6
    v_mul_u32_u24 v6, 4288, v6
    v_lshrrev_b32 v7, 2, v4
    v_lshlrev_b32 v7, 3, v7
    v_lshlrev_b32 v8, 4, v5
    v_add_u32 v6, v6, v8
    v_sub_u32 v6, v6, v7
    v_add_u32 v6, 24, v6
    v_add_u32 v6, s26, v6
    v_lshlrev_b32 v7, 5, v4
    v_add3_u32 v7, v7, v8, s26
    v_add_u32 v7, 17152, v7
    s_lshl_b32 s3, s21, 8
    v_mov_b32 v11, s3
    v_mov_b32 v12, 1
    v_mov_b32 v16, 0
    v_mov_b32 v17, 0
    v_mov_b32 v18, 0
    v_mov_b32 v19, 0
    v_mov_b32 v20, 0
    v_mov_b32 v21, 0
    v_mov_b32 v22, 0
    v_mov_b32 v23, 0
    v_mov_b32 v24, 0
    v_mov_b32 v25, 0
    v_mov_b32 v26, 0
    v_mov_b32 v27, 0
    v_mov_b32 v28, 0
    v_mov_b32 v29, 0
    v_mov_b32 v30, 0
    v_mov_b32 v31, 0
    v_mov_b32 v32, 0
    v_mov_b32 v33, 0
    v_mov_b32 v34, 0
    v_mov_b32 v35, 0
    v_mov_b32 v36, 0
    v_mov_b32 v37, 0
    v_mov_b32 v38, 0
    v_mov_b32 v39, 0
    v_mov_b32 v40, 0
    v_mov_b32 v41, 0
    v_mov_b32 v42, 0
    v_mov_b32 v43, 0
    v_mov_b32 v44, 0
    v_mov_b32 v45, 0
    v_mov_b32 v46, 0
    v_mov_b32 v47, 0
    s_waitcnt vmcnt(4) lgkmcnt(0)
    ds_read_b128 v[84:87], v7 offset:0
    ds_read_b64 v[48:49], v6 offset:4096
    ds_read_b64 v[50:51], v6 offset:4104
    ds_read_b128 v[88:91], v7 offset:512
    ds_read_b64 v[52:53], v6 offset:3584
    ds_read_b64 v[54:55], v6 offset:3592
    ds_read_b128 v[92:95], v7 offset:1024
    ds_read_b64 v[56:57], v6 offset:3072
    ds_read_b64 v[58:59], v6 offset:3080
    ds_read_b128 v[96:99], v7 offset:1536
    ds_read_b64 v[60:61], v6 offset:2560
    ds_read_b64 v[62:63], v6 offset:2568
    ds_read_b128 v[100:103], v7 offset:2048
    ds_read_b64 v[64:65], v6 offset:2048
    ds_read_b64 v[66:67], v6 offset:2056
    ds_read_b128 v[104:107], v7 offset:2560
    ds_read_b64 v[68:69], v6 offset:1536
    ds_read_b64 v[70:71], v6 offset:1544
    ds_read_b128 v[108:111], v7 offset:3072
    ds_read_b64 v[72:73], v6 offset:1024
    ds_read_b64 v[74:75], v6 offset:1032
    ds_read_b128 v[112:115], v7 offset:3584
    ds_read_b64 v[76:77], v6 offset:512
    ds_read_b64 v[78:79], v6 offset:520
    ds_read_b128 v[116:119], v7 offset:4096
    ds_read_b64 v[80:81], v6 offset:0
    ds_read_b64 v[82:83], v6 offset:8
    s_waitcnt lgkmcnt(0)
    v_mfma_f32_16x16x32_bf16 v[16:19], v[48:51], v[88:91], v[16:19]
    ds_read_b128 v[160:163], v7 offset:448
    v_mfma_f32_16x16x32_bf16 v[20:23], v[48:51], v[92:95], v[20:23]
    ds_read_b64 v[120:121], v6 offset:4032
    v_mfma_f32_16x16x32_bf16 v[24:27], v[48:51], v[96:99], v[24:27]
    ds_read_b64 v[122:123], v6 offset:4040
    v_mfma_f32_16x16x32_bf16 v[28:31], v[48:51], v[100:103], v[28:31]
    ds_read_b128 v[164:167], v7 offset:960
    v_mfma_f32_16x16x32_bf16 v[32:35], v[48:51], v[104:107], v[32:35]
    ds_read_b64 v[124:125], v6 offset:3520
    v_mfma_f32_16x16x32_bf16 v[36:39], v[48:51], v[108:111], v[36:39]
    ds_read_b64 v[126:127], v6 offset:3528
    v_mfma_f32_16x16x32_bf16 v[40:43], v[48:51], v[112:115], v[40:43]
    ds_read_b128 v[168:171], v7 offset:1472
    v_mfma_f32_16x16x32_bf16 v[44:47], v[48:51], v[116:119], v[44:47]
    ds_read_b64 v[128:129], v6 offset:3008
    v_mfma_f32_16x16x32_bf16 v[16:19], v[52:55], v[84:87], v[16:19]
    ds_read_b64 v[130:131], v6 offset:3016
    v_mfma_f32_16x16x32_bf16 v[20:23], v[52:55], v[88:91], v[20:23]
    ds_read_b128 v[172:175], v7 offset:1984
    v_mfma_f32_16x16x32_bf16 v[24:27], v[52:55], v[92:95], v[24:27]
    ds_read_b64 v[132:133], v6 offset:2496
    v_mfma_f32_16x16x32_bf16 v[28:31], v[52:55], v[96:99], v[28:31]
    ds_read_b64 v[134:135], v6 offset:2504
    v_mfma_f32_16x16x32_bf16 v[32:35], v[52:55], v[100:103], v[32:35]
    ds_read_b128 v[176:179], v7 offset:2496
    v_mfma_f32_16x16x32_bf16 v[36:39], v[52:55], v[104:107], v[36:39]
    ds_read_b64 v[136:137], v6 offset:1984
    v_mfma_f32_16x16x32_bf16 v[40:43], v[52:55], v[108:111], v[40:43]
    ds_read_b64 v[138:139], v6 offset:1992
    v_mfma_f32_16x16x32_bf16 v[44:47], v[52:55], v[112:115], v[44:47]
    ds_read_b128 v[180:183], v7 offset:3008
    v_mfma_f32_16x16x32_bf16 v[20:23], v[56:59], v[84:87], v[20:23]
    ds_read_b64 v[140:141], v6 offset:1472
    v_mfma_f32_16x16x32_bf16 v[24:27], v[56:59], v[88:91], v[24:27]
    ds_read_b64 v[142:143], v6 offset:1480
    v_mfma_f32_16x16x32_bf16 v[28:31], v[56:59], v[92:95], v[28:31]
    ds_read_b128 v[184:187], v7 offset:3520
    v_mfma_f32_16x16x32_bf16 v[32:35], v[56:59], v[96:99], v[32:35]
    ds_read_b64 v[144:145], v6 offset:960
    v_mfma_f32_16x16x32_bf16 v[36:39], v[56:59], v[100:103], v[36:39]
    ds_read_b64 v[146:147], v6 offset:968
    v_mfma_f32_16x16x32_bf16 v[40:43], v[56:59], v[104:107], v[40:43]
    ds_read_b128 v[188:191], v7 offset:4032
    v_mfma_f32_16x16x32_bf16 v[44:47], v[56:59], v[108:111], v[44:47]
    ds_read_b64 v[148:149], v6 offset:448
    v_mfma_f32_16x16x32_bf16 v[24:27], v[60:63], v[84:87], v[24:27]
    ds_read_b64 v[150:151], v6 offset:456
    v_mfma_f32_16x16x32_bf16 v[28:31], v[60:63], v[88:91], v[28:31]
    s_add_u32 m0, s27, 0
    s_add_u32 s29, s28, 0
    buffer_load_dwordx4 v13, s[52:55], s29 offen lds
    v_mfma_f32_16x16x32_bf16 v[32:35], v[60:63], v[92:95], v[32:35]
    s_add_u32 m0, s27, 1024
    s_add_u32 s29, s28, 16384
    buffer_load_dwordx4 v13, s[52:55], s29 offen lds
    v_mfma_f32_16x16x32_bf16 v[36:39], v[60:63], v[96:99], v[36:39]
    s_add_u32 m0, s27, 2048
    s_add_u32 s29, s28, 32768
    buffer_load_dwordx4 v13, s[52:55], s29 offen lds
    v_mfma_f32_16x16x32_bf16 v[40:43], v[60:63], v[100:103], v[40:43]
    s_add_u32 m0, s27, 3072
    s_add_u32 s29, s28, 49152
    buffer_load_dwordx4 v13, s[52:55], s29 offen lds
    v_mfma_f32_16x16x32_bf16 v[44:47], v[60:63], v[104:107], v[44:47]
    s_add_u32 m0, s27, 4096
    s_add_u32 s29, s28, 65536
    buffer_load_dwordx4 v13, s[52:55], s29 offen lds
    v_mfma_f32_16x16x32_bf16 v[28:31], v[64:67], v[84:87], v[28:31]
    s_add_u32 m0, s27, 5120
    s_add_u32 s29, s28, 81920
    buffer_load_dwordx4 v13, s[52:55], s29 offen lds
    v_mfma_f32_16x16x32_bf16 v[32:35], v[64:67], v[88:91], v[32:35]
    s_add_u32 m0, s27, 6144
    s_add_u32 s29, s28, 98304
    buffer_load_dwordx4 v13, s[52:55], s29 offen lds
    v_mfma_f32_16x16x32_bf16 v[36:39], v[64:67], v[92:95], v[36:39]
    s_add_u32 m0, s27, 7168
    s_add_u32 s29, s28, 114688
    buffer_load_dwordx4 v13, s[52:55], s29 offen lds
    v_mfma_f32_16x16x32_bf16 v[40:43], v[64:67], v[96:99], v[40:43]
    v_mfma_f32_16x16x32_bf16 v[44:47], v[64:67], v[100:103], v[44:47]
    v_mfma_f32_16x16x32_bf16 v[32:35], v[68:71], v[84:87], v[32:35]
    v_mfma_f32_16x16x32_bf16 v[36:39], v[68:71], v[88:91], v[36:39]
    v_mfma_f32_16x16x32_bf16 v[40:43], v[68:71], v[92:95], v[40:43]
    v_mfma_f32_16x16x32_bf16 v[44:47], v[68:71], v[96:99], v[44:47]
    v_mfma_f32_16x16x32_bf16 v[36:39], v[72:75], v[84:87], v[36:39]
    v_mfma_f32_16x16x32_bf16 v[40:43], v[72:75], v[88:91], v[40:43]
    v_mfma_f32_16x16x32_bf16 v[44:47], v[72:75], v[92:95], v[44:47]
    v_mfma_f32_16x16x32_bf16 v[40:43], v[76:79], v[84:87], v[40:43]
    v_mfma_f32_16x16x32_bf16 v[44:47], v[76:79], v[88:91], v[44:47]
    v_mfma_f32_16x16x32_bf16 v[44:47], v[80:83], v[84:87], v[44:47]
    s_waitcnt lgkmcnt(0)
    v_mfma_f32_16x16x32_bf16 v[16:19], v[120:123], v[160:163], v[16:19]
    ds_read_b128 v[88:91], v7 offset:384
    v_mfma_f32_16x16x32_bf16 v[20:23], v[120:123], v[164:167], v[20:23]
    ds_read_b64 v[48:49], v6 offset:3968
    v_mfma_f32_16x16x32_bf16 v[24:27], v[120:123], v[168:171], v[24:27]
    ds_read_b64 v[50:51], v6 offset:3976
    v_mfma_f32_16x16x32_bf16 v[28:31], v[120:123], v[172:175], v[28:31]
    ds_read_b128 v[92:95], v7 offset:896
    v_mfma_f32_16x16x32_bf16 v[32:35], v[120:123], v[176:179], v[32:35]
    ds_read_b64 v[52:53], v6 offset:3456
    v_mfma_f32_16x16x32_bf16 v[36:39], v[120:123], v[180:183], v[36:39]
    ds_read_b64 v[54:55], v6 offset:3464
    v_mfma_f32_16x16x32_bf16 v[40:43], v[120:123], v[184:187], v[40:43]
    ds_read_b128 v[96:99], v7 offset:1408
    v_mfma_f32_16x16x32_bf16 v[44:47], v[120:123], v[188:191], v[44:47]
    ds_read_b64 v[56:57], v6 offset:2944
    v_mfma_f32_16x16x32_bf16 v[20:23], v[124:127], v[160:163], v[20:23]
    ds_read_b64 v[58:59], v6 offset:2952
    v_mfma_f32_16x16x32_bf16 v[24:27], v[124:127], v[164:167], v[24:27]
    ds_read_b128 v[100:103], v7 offset:1920
    v_mfma_f32_16x16x32_bf16 v[28:31], v[124:127], v[168:171], v[28:31]
    ds_read_b64 v[60:61], v6 offset:2432
    v_mfma_f32_16x16x32_bf16 v[32:35], v[124:127], v[172:175], v[32:35]
    ds_read_b64 v[62:63], v6 offset:2440
    v_mfma_f32_16x16x32_bf16 v[36:39], v[124:127], v[176:179], v[36:39]
    ds_read_b128 v[104:107], v7 offset:2432
    v_mfma_f32_16x16x32_bf16 v[40:43], v[124:127], v[180:183], v[40:43]
    ds_read_b64 v[64:65], v6 offset:1920
    v_mfma_f32_16x16x32_bf16 v[44:47], v[124:127], v[184:187], v[44:47]
    ds_read_b64 v[66:67], v6 offset:1928
    v_mfma_f32_16x16x32_bf16 v[24:27], v[128:131], v[160:163], v[24:27]
    ds_read_b128 v[108:111], v7 offset:2944
    v_mfma_f32_16x16x32_bf16 v[28:31], v[128:131], v[164:167], v[28:31]
    ds_read_b64 v[68:69], v6 offset:1408
    v_mfma_f32_16x16x32_bf16 v[32:35], v[128:131], v[168:171], v[32:35]
    ds_read_b64 v[70:71], v6 offset:1416
    v_mfma_f32_16x16x32_bf16 v[36:39], v[128:131], v[172:175], v[36:39]
    ds_read_b128 v[112:115], v7 offset:3456
    v_mfma_f32_16x16x32_bf16 v[40:43], v[128:131], v[176:179], v[40:43]
    ds_read_b64 v[72:73], v6 offset:896
    v_mfma_f32_16x16x32_bf16 v[44:47], v[128:131], v[180:183], v[44:47]
    ds_read_b64 v[74:75], v6 offset:904
    v_mfma_f32_16x16x32_bf16 v[28:31], v[132:135], v[160:163], v[28:31]
    ds_read_b128 v[116:119], v7 offset:3968
    v_mfma_f32_16x16x32_bf16 v[32:35], v[132:135], v[164:167], v[32:35]
    ds_read_b64 v[76:77], v6 offset:384
    v_mfma_f32_16x16x32_bf16 v[36:39], v[132:135], v[168:171], v[36:39]
    ds_read_b64 v[78:79], v6 offset:392
    v_mfma_f32_16x16x32_bf16 v[40:43], v[132:135], v[172:175], v[40:43]
    s_add_u32 m0, s27, 8192
    s_add_u32 s29, s28, 131072
    buffer_load_dwordx4 v13, s[52:55], s29 offen lds
    v_mfma_f32_16x16x32_bf16 v[44:47], v[132:135], v[176:179], v[44:47]
    s_add_u32 m0, s27, 9216
    s_add_u32 s29, s28, 147456
    buffer_load_dwordx4 v13, s[52:55], s29 offen lds
    v_mfma_f32_16x16x32_bf16 v[32:35], v[136:139], v[160:163], v[32:35]
    s_add_u32 m0, s27, 10240
    s_add_u32 s29, s28, 163840
    buffer_load_dwordx4 v13, s[52:55], s29 offen lds
    v_mfma_f32_16x16x32_bf16 v[36:39], v[136:139], v[164:167], v[36:39]
    s_add_u32 m0, s27, 11264
    s_add_u32 s29, s28, 180224
    buffer_load_dwordx4 v13, s[52:55], s29 offen lds
    v_mfma_f32_16x16x32_bf16 v[40:43], v[136:139], v[168:171], v[40:43]
    s_add_u32 m0, s27, 12288
    s_add_u32 s29, s28, 196608
    buffer_load_dwordx4 v13, s[52:55], s29 offen lds
    v_mfma_f32_16x16x32_bf16 v[44:47], v[136:139], v[172:175], v[44:47]
    s_add_u32 m0, s27, 13312
    s_add_u32 s29, s28, 212992
    buffer_load_dwordx4 v13, s[52:55], s29 offen lds
    v_mfma_f32_16x16x32_bf16 v[36:39], v[140:143], v[160:163], v[36:39]
    s_add_u32 m0, s27, 14336
    s_add_u32 s29, s28, 229376
    buffer_load_dwordx4 v13, s[52:55], s29 offen lds
    v_mfma_f32_16x16x32_bf16 v[40:43], v[140:143], v[164:167], v[40:43]
    s_add_u32 m0, s27, 15360
    s_add_u32 s29, s28, 245760
    buffer_load_dwordx4 v13, s[52:55], s29 offen lds
    v_mfma_f32_16x16x32_bf16 v[44:47], v[140:143], v[168:171], v[44:47]
    v_mfma_f32_16x16x32_bf16 v[40:43], v[144:147], v[160:163], v[40:43]
    v_mfma_f32_16x16x32_bf16 v[44:47], v[144:147], v[164:167], v[44:47]
    v_mfma_f32_16x16x32_bf16 v[44:47], v[148:151], v[160:163], v[44:47]
    s_waitcnt lgkmcnt(0)
    s_waitcnt vmcnt(16)
    v_cmp_eq_u32 vcc, 0, v1
    s_nop 0
    s_and_saveexec_b64 s[60:61], vcc
    buffer_atomic_add v12, v11, s[48:51], 0 offen
    s_mov_b64 exec, -1
    v_mfma_f32_16x16x32_bf16 v[16:19], v[48:51], v[88:91], v[16:19]
    ds_read_b128 v[160:163], v7 offset:320
    v_mfma_f32_16x16x32_bf16 v[20:23], v[48:51], v[92:95], v[20:23]
    ds_read_b64 v[120:121], v6 offset:3904
    v_mfma_f32_16x16x32_bf16 v[24:27], v[48:51], v[96:99], v[24:27]
    ds_read_b64 v[122:123], v6 offset:3912
    v_mfma_f32_16x16x32_bf16 v[28:31], v[48:51], v[100:103], v[28:31]
    ds_read_b128 v[164:167], v7 offset:832
    v_mfma_f32_16x16x32_bf16 v[32:35], v[48:51], v[104:107], v[32:35]
    ds_read_b64 v[124:125], v6 offset:3392
    v_mfma_f32_16x16x32_bf16 v[36:39], v[48:51], v[108:111], v[36:39]
    ds_read_b64 v[126:127], v6 offset:3400
    v_mfma_f32_16x16x32_bf16 v[40:43], v[48:51], v[112:115], v[40:43]
    ds_read_b128 v[168:171], v7 offset:1344
    v_mfma_f32_16x16x32_bf16 v[44:47], v[48:51], v[116:119], v[44:47]
    ds_read_b64 v[128:129], v6 offset:2880
    v_mfma_f32_16x16x32_bf16 v[20:23], v[52:55], v[88:91], v[20:23]
    ds_read_b64 v[130:131], v6 offset:2888
    v_mfma_f32_16x16x32_bf16 v[24:27], v[52:55], v[92:95], v[24:27]
    ds_read_b128 v[172:175], v7 offset:1856
    v_mfma_f32_16x16x32_bf16 v[28:31], v[52:55], v[96:99], v[28:31]
    ds_read_b64 v[132:133], v6 offset:2368
    v_mfma_f32_16x16x32_bf16 v[32:35], v[52:55], v[100:103], v[32:35]
    ds_read_b64 v[134:135], v6 offset:2376
    v_mfma_f32_16x16x32_bf16 v[36:39], v[52:55], v[104:107], v[36:39]
    ds_read_b128 v[176:179], v7 offset:2368
    v_mfma_f32_16x16x32_bf16 v[40:43], v[52:55], v[108:111], v[40:43]
    ds_read_b64 v[136:137], v6 offset:1856
    v_mfma_f32_16x16x32_bf16 v[44:47], v[52:55], v[112:115], v[44:47]
    ds_read_b64 v[138:139], v6 offset:1864
    v_mfma_f32_16x16x32_bf16 v[24:27], v[56:59], v[88:91], v[24:27]
    ds_read_b128 v[180:183], v7 offset:2880
    v_mfma_f32_16x16x32_bf16 v[28:31], v[56:59], v[92:95], v[28:31]
    ds_read_b64 v[140:141], v6 offset:1344
    v_mfma_f32_16x16x32_bf16 v[32:35], v[56:59], v[96:99], v[32:35]
    ds_read_b64 v[142:143], v6 offset:1352
    v_mfma_f32_16x16x32_bf16 v[36:39], v[56:59], v[100:103], v[36:39]
    ds_read_b128 v[184:187], v7 offset:3392
    v_mfma_f32_16x16x32_bf16 v[40:43], v[56:59], v[104:107], v[40:43]
    ds_read_b64 v[144:145], v6 offset:832
    v_mfma_f32_16x16x32_bf16 v[44:47], v[56:59], v[108:111], v[44:47]
    ds_read_b64 v[146:147], v6 offset:840
    v_mfma_f32_16x16x32_bf16 v[28:31], v[60:63], v[88:91], v[28:31]
    ds_read_b128 v[188:191], v7 offset:3904
    v_mfma_f32_16x16x32_bf16 v[32:35], v[60:63], v[92:95], v[32:35]
    ds_read_b64 v[148:149], v6 offset:320
    v_mfma_f32_16x16x32_bf16 v[36:39], v[60:63], v[96:99], v[36:39]
    ds_read_b64 v[150:151], v6 offset:328
    v_mfma_f32_16x16x32_bf16 v[40:43], v[60:63], v[100:103], v[40:43]
    v_mfma_f32_16x16x32_bf16 v[44:47], v[60:63], v[104:107], v[44:47]
    v_mfma_f32_16x16x32_bf16 v[32:35], v[64:67], v[88:91], v[32:35]
    v_mfma_f32_16x16x32_bf16 v[36:39], v[64:67], v[92:95], v[36:39]
    v_mfma_f32_16x16x32_bf16 v[40:43], v[64:67], v[96:99], v[40:43]
    v_mfma_f32_16x16x32_bf16 v[44:47], v[64:67], v[100:103], v[44:47]
    v_mfma_f32_16x16x32_bf16 v[36:39], v[68:71], v[88:91], v[36:39]
    v_mfma_f32_16x16x32_bf16 v[40:43], v[68:71], v[92:95], v[40:43]
    v_mfma_f32_16x16x32_bf16 v[44:47], v[68:71], v[96:99], v[44:47]
    v_mfma_f32_16x16x32_bf16 v[40:43], v[72:75], v[88:91], v[40:43]
    v_mfma_f32_16x16x32_bf16 v[44:47], v[72:75], v[92:95], v[44:47]
    v_mfma_f32_16x16x32_bf16 v[44:47], v[76:79], v[88:91], v[44:47]
    s_lshl_b32 s28, s18, 2
    s_add_u32 s28, s28, s22
    s_lshl_b32 s28, s28, 16
    s_add_u32 s28, s28, 16777216
    s_lshr_b32 s3, s18, 1
    s_lshl_b32 s3, s3, 8
    v_mov_b32 v3, s3
    s_waitcnt lgkmcnt(0)
    v_mfma_f32_16x16x32_bf16 v[16:19], v[120:123], v[160:163], v[16:19]
    ds_read_b128 v[88:91], v7 offset:256
    v_mfma_f32_16x16x32_bf16 v[20:23], v[120:123], v[164:167], v[20:23]
    ds_read_b64 v[48:49], v6 offset:3840
    v_mfma_f32_16x16x32_bf16 v[24:27], v[120:123], v[168:171], v[24:27]
    ds_read_b64 v[50:51], v6 offset:3848
    v_mfma_f32_16x16x32_bf16 v[28:31], v[120:123], v[172:175], v[28:31]
    ds_read_b128 v[92:95], v7 offset:768
    v_mfma_f32_16x16x32_bf16 v[32:35], v[120:123], v[176:179], v[32:35]
    ds_read_b64 v[52:53], v6 offset:3328
    v_mfma_f32_16x16x32_bf16 v[36:39], v[120:123], v[180:183], v[36:39]
    ds_read_b64 v[54:55], v6 offset:3336
    v_mfma_f32_16x16x32_bf16 v[40:43], v[120:123], v[184:187], v[40:43]
    ds_read_b128 v[96:99], v7 offset:1280
    v_mfma_f32_16x16x32_bf16 v[44:47], v[120:123], v[188:191], v[44:47]
    ds_read_b64 v[56:57], v6 offset:2816
    v_mfma_f32_16x16x32_bf16 v[20:23], v[124:127], v[160:163], v[20:23]
    ds_read_b64 v[58:59], v6 offset:2824
    v_mfma_f32_16x16x32_bf16 v[24:27], v[124:127], v[164:167], v[24:27]
    ds_read_b128 v[100:103], v7 offset:1792
    v_mfma_f32_16x16x32_bf16 v[28:31], v[124:127], v[168:171], v[28:31]
    ds_read_b64 v[60:61], v6 offset:2304
    v_mfma_f32_16x16x32_bf16 v[32:35], v[124:127], v[172:175], v[32:35]
    ds_read_b64 v[62:63], v6 offset:2312
    v_mfma_f32_16x16x32_bf16 v[36:39], v[124:127], v[176:179], v[36:39]
    ds_read_b128 v[104:107], v7 offset:2304
    v_mfma_f32_16x16x32_bf16 v[40:43], v[124:127], v[180:183], v[40:43]
    ds_read_b64 v[64:65], v6 offset:1792
    v_mfma_f32_16x16x32_bf16 v[44:47], v[124:127], v[184:187], v[44:47]
    ds_read_b64 v[66:67], v6 offset:1800
    v_mfma_f32_16x16x32_bf16 v[24:27], v[128:131], v[160:163], v[24:27]
    ds_read_b128 v[108:111], v7 offset:2816
    v_mfma_f32_16x16x32_bf16 v[28:31], v[128:131], v[164:167], v[28:31]
    ds_read_b64 v[68:69], v6 offset:1280
    v_mfma_f32_16x16x32_bf16 v[32:35], v[128:131], v[168:171], v[32:35]
    ds_read_b64 v[70:71], v6 offset:1288
    v_mfma_f32_16x16x32_bf16 v[36:39], v[128:131], v[172:175], v[36:39]
    ds_read_b128 v[112:115], v7 offset:3328
    v_mfma_f32_16x16x32_bf16 v[40:43], v[128:131], v[176:179], v[40:43]
    ds_read_b64 v[72:73], v6 offset:768
    v_mfma_f32_16x16x32_bf16 v[44:47], v[128:131], v[180:183], v[44:47]
    ds_read_b64 v[74:75], v6 offset:776
    v_mfma_f32_16x16x32_bf16 v[28:31], v[132:135], v[160:163], v[28:31]
    ds_read_b128 v[116:119], v7 offset:3840
    v_mfma_f32_16x16x32_bf16 v[32:35], v[132:135], v[164:167], v[32:35]
    ds_read_b64 v[76:77], v6 offset:256
    v_mfma_f32_16x16x32_bf16 v[36:39], v[132:135], v[168:171], v[36:39]
    ds_read_b64 v[78:79], v6 offset:264
    v_mfma_f32_16x16x32_bf16 v[40:43], v[132:135], v[172:175], v[40:43]
    v_mfma_f32_16x16x32_bf16 v[44:47], v[132:135], v[176:179], v[44:47]
    v_mfma_f32_16x16x32_bf16 v[32:35], v[136:139], v[160:163], v[32:35]
    v_mfma_f32_16x16x32_bf16 v[36:39], v[136:139], v[164:167], v[36:39]
    v_mfma_f32_16x16x32_bf16 v[40:43], v[136:139], v[168:171], v[40:43]
    v_mfma_f32_16x16x32_bf16 v[44:47], v[136:139], v[172:175], v[44:47]
    v_mfma_f32_16x16x32_bf16 v[36:39], v[140:143], v[160:163], v[36:39]
    v_mfma_f32_16x16x32_bf16 v[40:43], v[140:143], v[164:167], v[40:43]
    v_mfma_f32_16x16x32_bf16 v[44:47], v[140:143], v[168:171], v[44:47]
    v_mfma_f32_16x16x32_bf16 v[40:43], v[144:147], v[160:163], v[40:43]
    v_mfma_f32_16x16x32_bf16 v[44:47], v[144:147], v[164:167], v[44:47]
    v_mfma_f32_16x16x32_bf16 v[44:47], v[148:151], v[160:163], v[44:47]
    s_waitcnt lgkmcnt(0)
    v_mfma_f32_16x16x32_bf16 v[16:19], v[48:51], v[88:91], v[16:19]
    ds_read_b128 v[160:163], v7 offset:192
    v_mfma_f32_16x16x32_bf16 v[20:23], v[48:51], v[92:95], v[20:23]
    ds_read_b64 v[120:121], v6 offset:3776
    v_mfma_f32_16x16x32_bf16 v[24:27], v[48:51], v[96:99], v[24:27]
    ds_read_b64 v[122:123], v6 offset:3784
    v_mfma_f32_16x16x32_bf16 v[28:31], v[48:51], v[100:103], v[28:31]
    ds_read_b128 v[164:167], v7 offset:704
    v_mfma_f32_16x16x32_bf16 v[32:35], v[48:51], v[104:107], v[32:35]
    ds_read_b64 v[124:125], v6 offset:3264
    v_mfma_f32_16x16x32_bf16 v[36:39], v[48:51], v[108:111], v[36:39]
    ds_read_b64 v[126:127], v6 offset:3272
    v_mfma_f32_16x16x32_bf16 v[40:43], v[48:51], v[112:115], v[40:43]
    ds_read_b128 v[168:171], v7 offset:1216
    v_mfma_f32_16x16x32_bf16 v[44:47], v[48:51], v[116:119], v[44:47]
    ds_read_b64 v[128:129], v6 offset:2752
    v_mfma_f32_16x16x32_bf16 v[20:23], v[52:55], v[88:91], v[20:23]
    ds_read_b64 v[130:131], v6 offset:2760
    v_mfma_f32_16x16x32_bf16 v[24:27], v[52:55], v[92:95], v[24:27]
    ds_read_b128 v[172:175], v7 offset:1728
    v_mfma_f32_16x16x32_bf16 v[28:31], v[52:55], v[96:99], v[28:31]
    ds_read_b64 v[132:133], v6 offset:2240
    v_mfma_f32_16x16x32_bf16 v[32:35], v[52:55], v[100:103], v[32:35]
    ds_read_b64 v[134:135], v6 offset:2248
    v_mfma_f32_16x16x32_bf16 v[36:39], v[52:55], v[104:107], v[36:39]
    ds_read_b128 v[176:179], v7 offset:2240
    v_mfma_f32_16x16x32_bf16 v[40:43], v[52:55], v[108:111], v[40:43]
    ds_read_b64 v[136:137], v6 offset:1728
    v_mfma_f32_16x16x32_bf16 v[44:47], v[52:55], v[112:115], v[44:47]
    ds_read_b64 v[138:139], v6 offset:1736
    v_mfma_f32_16x16x32_bf16 v[24:27], v[56:59], v[88:91], v[24:27]
    ds_read_b128 v[180:183], v7 offset:2752
    v_mfma_f32_16x16x32_bf16 v[28:31], v[56:59], v[92:95], v[28:31]
    ds_read_b64 v[140:141], v6 offset:1216
    v_mfma_f32_16x16x32_bf16 v[32:35], v[56:59], v[96:99], v[32:35]
    ds_read_b64 v[142:143], v6 offset:1224
    v_mfma_f32_16x16x32_bf16 v[36:39], v[56:59], v[100:103], v[36:39]
    ds_read_b128 v[184:187], v7 offset:3264
    v_mfma_f32_16x16x32_bf16 v[40:43], v[56:59], v[104:107], v[40:43]
    ds_read_b64 v[144:145], v6 offset:704
    v_mfma_f32_16x16x32_bf16 v[44:47], v[56:59], v[108:111], v[44:47]
    ds_read_b64 v[146:147], v6 offset:712
    v_mfma_f32_16x16x32_bf16 v[28:31], v[60:63], v[88:91], v[28:31]
    ds_read_b128 v[188:191], v7 offset:3776
    v_mfma_f32_16x16x32_bf16 v[32:35], v[60:63], v[92:95], v[32:35]
    ds_read_b64 v[148:149], v6 offset:192
    v_mfma_f32_16x16x32_bf16 v[36:39], v[60:63], v[96:99], v[36:39]
    ds_read_b64 v[150:151], v6 offset:200
    v_mfma_f32_16x16x32_bf16 v[40:43], v[60:63], v[100:103], v[40:43]
    v_mfma_f32_16x16x32_bf16 v[44:47], v[60:63], v[104:107], v[44:47]
    v_mfma_f32_16x16x32_bf16 v[32:35], v[64:67], v[88:91], v[32:35]
    v_mfma_f32_16x16x32_bf16 v[36:39], v[64:67], v[92:95], v[36:39]
    v_mfma_f32_16x16x32_bf16 v[40:43], v[64:67], v[96:99], v[40:43]
    v_mfma_f32_16x16x32_bf16 v[44:47], v[64:67], v[100:103], v[44:47]
    v_mfma_f32_16x16x32_bf16 v[36:39], v[68:71], v[88:91], v[36:39]
    v_mfma_f32_16x16x32_bf16 v[40:43], v[68:71], v[92:95], v[40:43]
    v_mfma_f32_16x16x32_bf16 v[44:47], v[68:71], v[96:99], v[44:47]
    v_mfma_f32_16x16x32_bf16 v[40:43], v[72:75], v[88:91], v[40:43]
    v_mfma_f32_16x16x32_bf16 v[44:47], v[72:75], v[92:95], v[44:47]
    v_mfma_f32_16x16x32_bf16 v[44:47], v[76:79], v[88:91], v[44:47]
    s_waitcnt lgkmcnt(0)
    v_mfma_f32_16x16x32_bf16 v[16:19], v[120:123], v[160:163], v[16:19]
    ds_read_b128 v[88:91], v7 offset:128
    v_mfma_f32_16x16x32_bf16 v[20:23], v[120:123], v[164:167], v[20:23]
    ds_read_b64 v[48:49], v6 offset:3712
    v_mfma_f32_16x16x32_bf16 v[24:27], v[120:123], v[168:171], v[24:27]
    ds_read_b64 v[50:51], v6 offset:3720
    v_mfma_f32_16x16x32_bf16 v[28:31], v[120:123], v[172:175], v[28:31]
    ds_read_b128 v[92:95], v7 offset:640
    v_mfma_f32_16x16x32_bf16 v[32:35], v[120:123], v[176:179], v[32:35]
    ds_read_b64 v[52:53], v6 offset:3200
    v_mfma_f32_16x16x32_bf16 v[36:39], v[120:123], v[180:183], v[36:39]
    ds_read_b64 v[54:55], v6 offset:3208
    v_mfma_f32_16x16x32_bf16 v[40:43], v[120:123], v[184:187], v[40:43]
    ds_read_b128 v[96:99], v7 offset:1152
    v_mfma_f32_16x16x32_bf16 v[44:47], v[120:123], v[188:191], v[44:47]
    ds_read_b64 v[56:57], v6 offset:2688
    v_mfma_f32_16x16x32_bf16 v[20:23], v[124:127], v[160:163], v[20:23]
    ds_read_b64 v[58:59], v6 offset:2696
    v_mfma_f32_16x16x32_bf16 v[24:27], v[124:127], v[164:167], v[24:27]
    ds_read_b128 v[100:103], v7 offset:1664
    v_mfma_f32_16x16x32_bf16 v[28:31], v[124:127], v[168:171], v[28:31]
    ds_read_b64 v[60:61], v6 offset:2176
    v_mfma_f32_16x16x32_bf16 v[32:35], v[124:127], v[172:175], v[32:35]
    ds_read_b64 v[62:63], v6 offset:2184
    v_mfma_f32_16x16x32_bf16 v[36:39], v[124:127], v[176:179], v[36:39]
    ds_read_b128 v[104:107], v7 offset:2176
    v_mfma_f32_16x16x32_bf16 v[40:43], v[124:127], v[180:183], v[40:43]
    ds_read_b64 v[64:65], v6 offset:1664
    v_mfma_f32_16x16x32_bf16 v[44:47], v[124:127], v[184:187], v[44:47]
    ds_read_b64 v[66:67], v6 offset:1672
    v_mfma_f32_16x16x32_bf16 v[24:27], v[128:131], v[160:163], v[24:27]
    ds_read_b128 v[108:111], v7 offset:2688
    v_mfma_f32_16x16x32_bf16 v[28:31], v[128:131], v[164:167], v[28:31]
    ds_read_b64 v[68:69], v6 offset:1152
    v_mfma_f32_16x16x32_bf16 v[32:35], v[128:131], v[168:171], v[32:35]
    ds_read_b64 v[70:71], v6 offset:1160
    v_mfma_f32_16x16x32_bf16 v[36:39], v[128:131], v[172:175], v[36:39]
    ds_read_b128 v[112:115], v7 offset:3200
    v_mfma_f32_16x16x32_bf16 v[40:43], v[128:131], v[176:179], v[40:43]
    ds_read_b64 v[72:73], v6 offset:640
    v_mfma_f32_16x16x32_bf16 v[44:47], v[128:131], v[180:183], v[44:47]
    ds_read_b64 v[74:75], v6 offset:648
    v_mfma_f32_16x16x32_bf16 v[28:31], v[132:135], v[160:163], v[28:31]
    ds_read_b128 v[116:119], v7 offset:3712
    v_mfma_f32_16x16x32_bf16 v[32:35], v[132:135], v[164:167], v[32:35]
    ds_read_b64 v[76:77], v6 offset:128
    v_mfma_f32_16x16x32_bf16 v[36:39], v[132:135], v[168:171], v[36:39]
    ds_read_b64 v[78:79], v6 offset:136
    v_mfma_f32_16x16x32_bf16 v[40:43], v[132:135], v[172:175], v[40:43]
    v_mfma_f32_16x16x32_bf16 v[44:47], v[132:135], v[176:179], v[44:47]
    v_mfma_f32_16x16x32_bf16 v[32:35], v[136:139], v[160:163], v[32:35]
    v_mfma_f32_16x16x32_bf16 v[36:39], v[136:139], v[164:167], v[36:39]
    v_mfma_f32_16x16x32_bf16 v[40:43], v[136:139], v[168:171], v[40:43]
    v_mfma_f32_16x16x32_bf16 v[44:47], v[136:139], v[172:175], v[44:47]
    v_mfma_f32_16x16x32_bf16 v[36:39], v[140:143], v[160:163], v[36:39]
    v_mfma_f32_16x16x32_bf16 v[40:43], v[140:143], v[164:167], v[40:43]
    v_mfma_f32_16x16x32_bf16 v[44:47], v[140:143], v[168:171], v[44:47]
    v_mfma_f32_16x16x32_bf16 v[40:43], v[144:147], v[160:163], v[40:43]
    v_mfma_f32_16x16x32_bf16 v[44:47], v[144:147], v[164:167], v[44:47]
    v_mfma_f32_16x16x32_bf16 v[44:47], v[148:151], v[160:163], v[44:47]
    s_waitcnt lgkmcnt(0)
    v_mfma_f32_16x16x32_bf16 v[16:19], v[48:51], v[88:91], v[16:19]
    ds_read_b128 v[160:163], v7 offset:64
    v_mfma_f32_16x16x32_bf16 v[20:23], v[48:51], v[92:95], v[20:23]
    ds_read_b64 v[120:121], v6 offset:3648
    v_mfma_f32_16x16x32_bf16 v[24:27], v[48:51], v[96:99], v[24:27]
    ds_read_b64 v[122:123], v6 offset:3656
    v_mfma_f32_16x16x32_bf16 v[28:31], v[48:51], v[100:103], v[28:31]
    ds_read_b128 v[164:167], v7 offset:576
    v_mfma_f32_16x16x32_bf16 v[32:35], v[48:51], v[104:107], v[32:35]
    ds_read_b64 v[124:125], v6 offset:3136
    v_mfma_f32_16x16x32_bf16 v[36:39], v[48:51], v[108:111], v[36:39]
    ds_read_b64 v[126:127], v6 offset:3144
    v_mfma_f32_16x16x32_bf16 v[40:43], v[48:51], v[112:115], v[40:43]
    ds_read_b128 v[168:171], v7 offset:1088
    v_mfma_f32_16x16x32_bf16 v[44:47], v[48:51], v[116:119], v[44:47]
    ds_read_b64 v[128:129], v6 offset:2624
    v_mfma_f32_16x16x32_bf16 v[20:23], v[52:55], v[88:91], v[20:23]
    ds_read_b64 v[130:131], v6 offset:2632
    v_mfma_f32_16x16x32_bf16 v[24:27], v[52:55], v[92:95], v[24:27]
    ds_read_b128 v[172:175], v7 offset:1600
    v_mfma_f32_16x16x32_bf16 v[28:31], v[52:55], v[96:99], v[28:31]
    ds_read_b64 v[132:133], v6 offset:2112
    v_mfma_f32_16x16x32_bf16 v[32:35], v[52:55], v[100:103], v[32:35]
    ds_read_b64 v[134:135], v6 offset:2120
    v_mfma_f32_16x16x32_bf16 v[36:39], v[52:55], v[104:107], v[36:39]
    ds_read_b128 v[176:179], v7 offset:2112
    v_mfma_f32_16x16x32_bf16 v[40:43], v[52:55], v[108:111], v[40:43]
    ds_read_b64 v[136:137], v6 offset:1600
    v_mfma_f32_16x16x32_bf16 v[44:47], v[52:55], v[112:115], v[44:47]
    ds_read_b64 v[138:139], v6 offset:1608
    v_mfma_f32_16x16x32_bf16 v[24:27], v[56:59], v[88:91], v[24:27]
    ds_read_b128 v[180:183], v7 offset:2624
    v_mfma_f32_16x16x32_bf16 v[28:31], v[56:59], v[92:95], v[28:31]
    ds_read_b64 v[140:141], v6 offset:1088
    v_mfma_f32_16x16x32_bf16 v[32:35], v[56:59], v[96:99], v[32:35]
    ds_read_b64 v[142:143], v6 offset:1096
    v_mfma_f32_16x16x32_bf16 v[36:39], v[56:59], v[100:103], v[36:39]
    ds_read_b128 v[184:187], v7 offset:3136
    v_mfma_f32_16x16x32_bf16 v[40:43], v[56:59], v[104:107], v[40:43]
    ds_read_b64 v[144:145], v6 offset:576
    v_mfma_f32_16x16x32_bf16 v[44:47], v[56:59], v[108:111], v[44:47]
    ds_read_b64 v[146:147], v6 offset:584
    v_mfma_f32_16x16x32_bf16 v[28:31], v[60:63], v[88:91], v[28:31]
    ds_read_b128 v[188:191], v7 offset:3648
    v_mfma_f32_16x16x32_bf16 v[32:35], v[60:63], v[92:95], v[32:35]
    ds_read_b64 v[148:149], v6 offset:64
    v_mfma_f32_16x16x32_bf16 v[36:39], v[60:63], v[96:99], v[36:39]
    ds_read_b64 v[150:151], v6 offset:72
    v_mfma_f32_16x16x32_bf16 v[40:43], v[60:63], v[100:103], v[40:43]
    v_mfma_f32_16x16x32_bf16 v[44:47], v[60:63], v[104:107], v[44:47]
    v_mfma_f32_16x16x32_bf16 v[32:35], v[64:67], v[88:91], v[32:35]
    v_mfma_f32_16x16x32_bf16 v[36:39], v[64:67], v[92:95], v[36:39]
    v_mfma_f32_16x16x32_bf16 v[40:43], v[64:67], v[96:99], v[40:43]
    v_mfma_f32_16x16x32_bf16 v[44:47], v[64:67], v[100:103], v[44:47]
    v_mfma_f32_16x16x32_bf16 v[36:39], v[68:71], v[88:91], v[36:39]
    v_mfma_f32_16x16x32_bf16 v[40:43], v[68:71], v[92:95], v[40:43]
    v_mfma_f32_16x16x32_bf16 v[44:47], v[68:71], v[96:99], v[44:47]
    v_mfma_f32_16x16x32_bf16 v[40:43], v[72:75], v[88:91], v[40:43]
    v_mfma_f32_16x16x32_bf16 v[44:47], v[72:75], v[92:95], v[44:47]
    v_mfma_f32_16x16x32_bf16 v[44:47], v[76:79], v[88:91], v[44:47]
    s_waitcnt lgkmcnt(0)
    v_mfma_f32_16x16x32_bf16 v[16:19], v[120:123], v[160:163], v[16:19]
    v_mfma_f32_16x16x32_bf16 v[20:23], v[120:123], v[164:167], v[20:23]
    v_mfma_f32_16x16x32_bf16 v[24:27], v[120:123], v[168:171], v[24:27]
    v_mfma_f32_16x16x32_bf16 v[28:31], v[120:123], v[172:175], v[28:31]
    v_mfma_f32_16x16x32_bf16 v[32:35], v[120:123], v[176:179], v[32:35]
    v_mfma_f32_16x16x32_bf16 v[36:39], v[120:123], v[180:183], v[36:39]
    v_mfma_f32_16x16x32_bf16 v[40:43], v[120:123], v[184:187], v[40:43]
    v_mfma_f32_16x16x32_bf16 v[44:47], v[120:123], v[188:191], v[44:47]
    v_mfma_f32_16x16x32_bf16 v[20:23], v[124:127], v[160:163], v[20:23]
    v_mfma_f32_16x16x32_bf16 v[24:27], v[124:127], v[164:167], v[24:27]
    v_mfma_f32_16x16x32_bf16 v[28:31], v[124:127], v[168:171], v[28:31]
    v_mfma_f32_16x16x32_bf16 v[32:35], v[124:127], v[172:175], v[32:35]
    v_mfma_f32_16x16x32_bf16 v[36:39], v[124:127], v[176:179], v[36:39]
    v_mfma_f32_16x16x32_bf16 v[40:43], v[124:127], v[180:183], v[40:43]
    v_mfma_f32_16x16x32_bf16 v[44:47], v[124:127], v[184:187], v[44:47]
    v_mfma_f32_16x16x32_bf16 v[24:27], v[128:131], v[160:163], v[24:27]
    v_mfma_f32_16x16x32_bf16 v[28:31], v[128:131], v[164:167], v[28:31]
    v_mfma_f32_16x16x32_bf16 v[32:35], v[128:131], v[168:171], v[32:35]
    v_mfma_f32_16x16x32_bf16 v[36:39], v[128:131], v[172:175], v[36:39]
    v_mfma_f32_16x16x32_bf16 v[40:43], v[128:131], v[176:179], v[40:43]
    v_mfma_f32_16x16x32_bf16 v[44:47], v[128:131], v[180:183], v[44:47]
    v_mfma_f32_16x16x32_bf16 v[28:31], v[132:135], v[160:163], v[28:31]
    v_mfma_f32_16x16x32_bf16 v[32:35], v[132:135], v[164:167], v[32:35]
    v_mfma_f32_16x16x32_bf16 v[36:39], v[132:135], v[168:171], v[36:39]
    v_mfma_f32_16x16x32_bf16 v[40:43], v[132:135], v[172:175], v[40:43]
    v_mfma_f32_16x16x32_bf16 v[44:47], v[132:135], v[176:179], v[44:47]
    v_mfma_f32_16x16x32_bf16 v[32:35], v[136:139], v[160:163], v[32:35]
    v_mfma_f32_16x16x32_bf16 v[36:39], v[136:139], v[164:167], v[36:39]
    v_mfma_f32_16x16x32_bf16 v[40:43], v[136:139], v[168:171], v[40:43]
    v_mfma_f32_16x16x32_bf16 v[44:47], v[136:139], v[172:175], v[44:47]
    v_mfma_f32_16x16x32_bf16 v[36:39], v[140:143], v[160:163], v[36:39]
    v_mfma_f32_16x16x32_bf16 v[40:43], v[140:143], v[164:167], v[40:43]
    v_mfma_f32_16x16x32_bf16 v[44:47], v[140:143], v[168:171], v[44:47]
    v_mfma_f32_16x16x32_bf16 v[40:43], v[144:147], v[160:163], v[40:43]
    v_mfma_f32_16x16x32_bf16 v[44:47], v[144:147], v[164:167], v[44:47]
    v_mfma_f32_16x16x32_bf16 v[44:47], v[148:151], v[160:163], v[44:47]
    v_lshlrev_b32 v8, 5, v4
    v_lshlrev_b32 v9, 3, v5
    v_add_u32 v8, v8, v9
    v_sub_u32 v9, 536, v8
    v_add_u32 v9, s26, v9
    v_lshlrev_b32 v14, 16, v14
    v_mov_b32 v15, v14
    s_add_u32 s27, s24, 20971520
    s_mov_b32 s30, 0xffff0000
    ds_read_b64 v[48:49], v9 offset:3584
    ds_read_b64 v[50:51], v9 offset:3072
    ds_read_b64 v[52:53], v9 offset:2560
    ds_read_b64 v[54:55], v9 offset:2048
    ds_read_b64 v[56:57], v9 offset:1536
    ds_read_b64 v[58:59], v9 offset:1024
    ds_read_b64 v[60:61], v9 offset:512
    ds_read_b64 v[62:63], v9 offset:0
    s_waitcnt lgkmcnt(0)
    s_lshl_b32 s25, s22, 18
    s_add_u32 s25, s25, 1048576
    s_add_u32 m0, s26, 0
    s_add_u32 s29, s25, 0
    buffer_load_dwordx4 v13, s[52:55], s29 offen lds
    s_add_u32 m0, s26, 1024
    s_add_u32 s29, s25, 16384
    buffer_load_dwordx4 v13, s[52:55], s29 offen lds
    s_add_u32 m0, s26, 2048
    s_add_u32 s29, s25, 32768
    buffer_load_dwordx4 v13, s[52:55], s29 offen lds
    s_add_u32 m0, s26, 3072
    s_add_u32 s29, s25, 49152
    buffer_load_dwordx4 v13, s[52:55], s29 offen lds
    s_add_u32 m0, s26, 4096
    s_add_u32 s29, s25, 65536
    buffer_load_dwordx4 v13, s[52:55], s29 offen lds
    s_add_u32 m0, s26, 5120
    s_add_u32 s29, s25, 81920
    buffer_load_dwordx4 v13, s[52:55], s29 offen lds
    s_add_u32 m0, s26, 6144
    s_add_u32 s29, s25, 98304
    buffer_load_dwordx4 v13, s[52:55], s29 offen lds
    s_add_u32 m0, s26, 7168
    s_add_u32 s29, s25, 114688
    buffer_load_dwordx4 v13, s[52:55], s29 offen lds
    s_add_u32 m0, s26, 8192
    s_add_u32 s29, s25, 131072
    buffer_load_dwordx4 v13, s[52:55], s29 offen lds
    s_add_u32 m0, s26, 9216
    s_add_u32 s29, s25, 147456
    buffer_load_dwordx4 v13, s[52:55], s29 offen lds
    s_add_u32 m0, s26, 10240
    s_add_u32 s29, s25, 163840
    buffer_load_dwordx4 v13, s[52:55], s29 offen lds
    s_add_u32 m0, s26, 11264
    s_add_u32 s29, s25, 180224
    buffer_load_dwordx4 v13, s[52:55], s29 offen lds
    s_add_u32 m0, s26, 12288
    s_add_u32 s29, s25, 196608
    buffer_load_dwordx4 v13, s[52:55], s29 offen lds
    s_add_u32 m0, s26, 13312
    s_add_u32 s29, s25, 212992
    buffer_load_dwordx4 v13, s[52:55], s29 offen lds
    s_add_u32 m0, s26, 14336
    s_add_u32 s29, s25, 229376
    buffer_load_dwordx4 v13, s[52:55], s29 offen lds
    s_add_u32 m0, s26, 15360
    s_add_u32 s29, s25, 245760
    buffer_load_dwordx4 v13, s[52:55], s29 offen lds
    v_and_b32 v128, s30, v49
    v_lshlrev_b32 v129, 16, v49
    v_and_b32 v130, s30, v48
    v_lshlrev_b32 v131, 16, v48
    v_pk_fma_f32 v[128:129], v[128:129], v[14:15], v[16:17]
    v_pk_fma_f32 v[130:131], v[130:131], v[14:15], v[18:19]
    v_cvt_pk_bf16_f32 v138, v128, v129
    v_cvt_pk_bf16_f32 v139, v130, v131
    buffer_store_dwordx2 v[138:139], v8, s[12:15], s27 offen offset:0 sc1
    v_and_b32 v144, s30, v51
    v_lshlrev_b32 v145, 16, v51
    v_and_b32 v146, s30, v50
    v_lshlrev_b32 v147, 16, v50
    v_pk_fma_f32 v[144:145], v[144:145], v[14:15], v[20:21]
    v_pk_fma_f32 v[146:147], v[146:147], v[14:15], v[22:23]
    v_cvt_pk_bf16_f32 v154, v144, v145
    v_cvt_pk_bf16_f32 v155, v146, v147
    buffer_store_dwordx2 v[154:155], v8, s[12:15], s27 offen offset:512 sc1
    v_and_b32 v160, s30, v53
    v_lshlrev_b32 v161, 16, v53
    v_and_b32 v162, s30, v52
    v_lshlrev_b32 v163, 16, v52
    v_pk_fma_f32 v[160:161], v[160:161], v[14:15], v[24:25]
    v_pk_fma_f32 v[162:163], v[162:163], v[14:15], v[26:27]
    v_cvt_pk_bf16_f32 v170, v160, v161
    v_cvt_pk_bf16_f32 v171, v162, v163
    buffer_store_dwordx2 v[170:171], v8, s[12:15], s27 offen offset:1024 sc1
    v_and_b32 v176, s30, v55
    v_lshlrev_b32 v177, 16, v55
    v_and_b32 v178, s30, v54
    v_lshlrev_b32 v179, 16, v54
    v_pk_fma_f32 v[176:177], v[176:177], v[14:15], v[28:29]
    v_pk_fma_f32 v[178:179], v[178:179], v[14:15], v[30:31]
    v_cvt_pk_bf16_f32 v186, v176, v177
    v_cvt_pk_bf16_f32 v187, v178, v179
    buffer_store_dwordx2 v[186:187], v8, s[12:15], s27 offen offset:1536 sc1
    v_and_b32 v128, s30, v57
    v_lshlrev_b32 v129, 16, v57
    v_and_b32 v130, s30, v56
    v_lshlrev_b32 v131, 16, v56
    v_pk_fma_f32 v[128:129], v[128:129], v[14:15], v[32:33]
    v_pk_fma_f32 v[130:131], v[130:131], v[14:15], v[34:35]
    v_cvt_pk_bf16_f32 v138, v128, v129
    v_cvt_pk_bf16_f32 v139, v130, v131
    buffer_store_dwordx2 v[138:139], v8, s[12:15], s27 offen offset:2048 sc1
    v_and_b32 v144, s30, v59
    v_lshlrev_b32 v145, 16, v59
    v_and_b32 v146, s30, v58
    v_lshlrev_b32 v147, 16, v58
    v_pk_fma_f32 v[144:145], v[144:145], v[14:15], v[36:37]
    v_pk_fma_f32 v[146:147], v[146:147], v[14:15], v[38:39]
    v_cvt_pk_bf16_f32 v154, v144, v145
    v_cvt_pk_bf16_f32 v155, v146, v147
    buffer_store_dwordx2 v[154:155], v8, s[12:15], s27 offen offset:2560 sc1
    v_and_b32 v160, s30, v61
    v_lshlrev_b32 v161, 16, v61
    v_and_b32 v162, s30, v60
    v_lshlrev_b32 v163, 16, v60
    v_pk_fma_f32 v[160:161], v[160:161], v[14:15], v[40:41]
    v_pk_fma_f32 v[162:163], v[162:163], v[14:15], v[42:43]
    v_cvt_pk_bf16_f32 v170, v160, v161
    v_cvt_pk_bf16_f32 v171, v162, v163
    buffer_store_dwordx2 v[170:171], v8, s[12:15], s27 offen offset:3072 sc1
    v_and_b32 v176, s30, v63
    v_lshlrev_b32 v177, 16, v63
    v_and_b32 v178, s30, v62
    v_lshlrev_b32 v179, 16, v62
    v_pk_fma_f32 v[176:177], v[176:177], v[14:15], v[44:45]
    v_pk_fma_f32 v[178:179], v[178:179], v[14:15], v[46:47]
    v_cvt_pk_bf16_f32 v186, v176, v177
    v_cvt_pk_bf16_f32 v187, v178, v179
    buffer_store_dwordx2 v[186:187], v8, s[12:15], s27 offen offset:3584 sc1
    v_lshlrev_b32 v7, 4, v1
    s_lshr_b32 s3, s2, 5
    s_lshl_b32 s3, s3, 8
    s_add_u32 s3, s3, 2048
    v_mov_b32 v14, s3
    s_cmp_lg_u32 s22, 0
    s_cbranch_scc1 L_k23_o_ok
L_k23_poll_o:
    buffer_load_dword v4, v3, s[48:51], 0 offen sc1
    s_waitcnt vmcnt(0)
    v_readfirstlane_b32 s3, v4
    s_nop 1
    s_cmp_ge_u32 s3, 128
    s_cbranch_scc1 L_k23_o_ok
    s_sleep 8
    s_branch L_k23_poll_o
L_k23_o_ok:
    s_waitcnt vmcnt(24)
    s_barrier
    s_add_u32 s29, s28, 0
    buffer_load_dwordx4 v[64:67], v7, s[12:15], s29 offen sc1
    s_add_u32 s29, s28, 1024
    buffer_load_dwordx4 v[68:71], v7, s[12:15], s29 offen sc1
    s_add_u32 s29, s28, 2048
    buffer_load_dwordx4 v[72:75], v7, s[12:15], s29 offen sc1
    s_add_u32 s29, s28, 3072
    buffer_load_dwordx4 v[76:79], v7, s[12:15], s29 offen sc1
    s_add_u32 s29, s28, 4096
    buffer_load_dwordx4 v[80:83], v7, s[12:15], s29 offen sc1
    s_add_u32 s29, s28, 5120
    buffer_load_dwordx4 v[84:87], v7, s[12:15], s29 offen sc1
    s_add_u32 s29, s28, 6144
    buffer_load_dwordx4 v[88:91], v7, s[12:15], s29 offen sc1
    s_add_u32 s29, s28, 7168
    buffer_load_dwordx4 v[92:95], v7, s[12:15], s29 offen sc1
    s_add_u32 s29, s28, 8192
    buffer_load_dwordx4 v[96:99], v7, s[12:15], s29 offen sc1
    s_add_u32 s29, s28, 9216
    buffer_load_dwordx4 v[100:103], v7, s[12:15], s29 offen sc1
    s_add_u32 s29, s28, 10240
    buffer_load_dwordx4 v[104:107], v7, s[12:15], s29 offen sc1
    s_add_u32 s29, s28, 11264
    buffer_load_dwordx4 v[108:111], v7, s[12:15], s29 offen sc1
    s_add_u32 s29, s28, 12288
    buffer_load_dwordx4 v[112:115], v7, s[12:15], s29 offen sc1
    s_add_u32 s29, s28, 13312
    buffer_load_dwordx4 v[116:119], v7, s[12:15], s29 offen sc1
    s_add_u32 s29, s28, 14336
    buffer_load_dwordx4 v[120:123], v7, s[12:15], s29 offen sc1
    s_add_u32 s29, s28, 15360
    buffer_load_dwordx4 v[124:127], v7, s[12:15], s29 offen sc1
    s_lshr_b32 s23, s2, 5
    s_lshl_b32 s23, s23, 7
    s_and_b32 s24, s2, 31
    s_lshl_b32 s24, s24, 6
    v_lshrrev_b32 v4, 3, v0
    v_and_b32 v5, 7, v0
    v_lshlrev_b32 v5, 4, v5
    v_add_u32 v3, s23, v4
    v_lshlrev_b32 v3, 12, v3
    v_add_u32 v3, v3, v5
    s_lshl_b32 s25, s24, 1
    s_add_u32 s25, s25, 20971520
    v_mul_u32_u24 v15, 144, v4
    v_add_u32 v15, v15, v5
    v_add_u32 v15, 87296, v15
    v_and_b32 v2, 15, v1
    v_lshrrev_b32 v4, 2, v2
    v_and_b32 v5, 3, v2
    v_lshrrev_b32 v9, 4, v1
    v_lshlrev_b32 v8, 3, v9
    v_add_u32 v8, v8, v4
    s_lshl_b32 s26, s22, 5
    v_add_u32 v8, s26, v8
    v_mul_u32_u24 v8, 144, v8
    v_lshlrev_b32 v5, 3, v5
    v_add_u32 v8, v8, v5
    v_add_u32 v8, 87296, v8
    v_add_u32 v2, s24, v2
    v_lshlrev_b32 v2, 12, v2
    v_lshlrev_b32 v9, 4, v9
    v_add_u32 v9, v2, v9
    s_lshl_b32 s26, s22, 6
    s_lshl_b32 s30, s23, 1
    s_add_u32 s26, s26, s30
    s_add_u32 s30, s26, 2048
    v_lshrrev_b32 v10, 5, v1
    v_lshlrev_b32 v10, 2, v10
    v_and_b32 v11, 15, v1
    v_lshrrev_b32 v11, 2, v11
    v_add_u32 v10, v10, v11
    v_lshlrev_b32 v10, 7, v10
    v_lshrrev_b32 v6, 4, v1
    v_and_b32 v6, 1, v6
    v_lshlrev_b32 v6, 1, v6
    v_and_b32 v13, 3, v1
    v_lshrrev_b32 v2, 1, v13
    v_add_u32 v6, v6, v2
    v_lshrrev_b32 v11, 1, v11
    v_and_b32 v11, 1, v11
    v_lshlrev_b32 v11, 2, v11
    v_xor_b32 v6, v6, v11
    v_lshlrev_b32 v6, 4, v6
    v_add_u32 v10, v10, v6
    v_and_b32 v13, 1, v13
    v_lshlrev_b32 v13, 3, v13
    v_add_u32 v6, v10, v13
    v_xor_b32 v13, 64, v6
    v_add_u32 v10, 87296, v6
    v_add_u32 v11, 87296, v13
    v_add_u32 v4, 65472, v6
    v_add_u32 v5, 65472, v13
    ds_read_b64_tr_b16 v[160:161], v10 offset:0
    ds_read_b64_tr_b16 v[162:163], v10 offset:1024
    ds_read_b64_tr_b16 v[164:165], v11 offset:0
    ds_read_b64_tr_b16 v[166:167], v11 offset:1024
    ds_read_b64_tr_b16 v[168:169], v10 offset:2048
    ds_read_b64_tr_b16 v[170:171], v10 offset:3072
    ds_read_b64_tr_b16 v[172:173], v11 offset:2048
    ds_read_b64_tr_b16 v[174:175], v11 offset:3072
    ds_read_b64_tr_b16 v[176:177], v10 offset:4096
    ds_read_b64_tr_b16 v[178:179], v10 offset:5120
    ds_read_b64_tr_b16 v[180:181], v11 offset:4096
    ds_read_b64_tr_b16 v[182:183], v11 offset:5120
    s_waitcnt vmcnt(8)
    s_waitcnt lgkmcnt(8)
    v_mfma_f32_32x32x16_bf16 v[32:47], v[160:163], v[64:67], 0
    ds_read_b64_tr_b16 v[184:185], v10 offset:6144
    ds_read_b64_tr_b16 v[186:187], v10 offset:7168
    v_mfma_f32_32x32x16_bf16 v[48:63], v[164:167], v[64:67], 0
    ds_read_b64_tr_b16 v[188:189], v11 offset:6144
    ds_read_b64_tr_b16 v[190:191], v11 offset:7168
    s_waitcnt lgkmcnt(8)
    v_mfma_f32_32x32x16_bf16 v[32:47], v[168:171], v[68:71], v[32:47]
    ds_read_b64_tr_b16 v[160:161], v10 offset:8192
    ds_read_b64_tr_b16 v[162:163], v10 offset:9216
    v_mfma_f32_32x32x16_bf16 v[48:63], v[172:175], v[68:71], v[48:63]
    ds_read_b64_tr_b16 v[164:165], v11 offset:8192
    ds_read_b64_tr_b16 v[166:167], v11 offset:9216
    s_waitcnt lgkmcnt(8)
    v_mfma_f32_32x32x16_bf16 v[32:47], v[176:179], v[72:75], v[32:47]
    ds_read_b64_tr_b16 v[168:169], v10 offset:10240
    ds_read_b64_tr_b16 v[170:171], v10 offset:11264
    v_mfma_f32_32x32x16_bf16 v[48:63], v[180:183], v[72:75], v[48:63]
    ds_read_b64_tr_b16 v[172:173], v11 offset:10240
    ds_read_b64_tr_b16 v[174:175], v11 offset:11264
    s_waitcnt lgkmcnt(8)
    v_mfma_f32_32x32x16_bf16 v[32:47], v[184:187], v[76:79], v[32:47]
    ds_read_b64_tr_b16 v[176:177], v10 offset:12288
    ds_read_b64_tr_b16 v[178:179], v10 offset:13312
    v_mfma_f32_32x32x16_bf16 v[48:63], v[188:191], v[76:79], v[48:63]
    ds_read_b64_tr_b16 v[180:181], v11 offset:12288
    ds_read_b64_tr_b16 v[182:183], v11 offset:13312
    s_waitcnt lgkmcnt(8)
    v_mfma_f32_32x32x16_bf16 v[32:47], v[160:163], v[80:83], v[32:47]
    ds_read_b64_tr_b16 v[184:185], v10 offset:14336
    ds_read_b64_tr_b16 v[186:187], v10 offset:15360
    v_mfma_f32_32x32x16_bf16 v[48:63], v[164:167], v[80:83], v[48:63]
    ds_read_b64_tr_b16 v[188:189], v11 offset:14336
    ds_read_b64_tr_b16 v[190:191], v11 offset:15360
    s_add_u32 s29, s28, 16384
    buffer_load_dwordx4 v[128:131], v7, s[12:15], s29 offen sc1
    s_add_u32 s29, s28, 17408
    buffer_load_dwordx4 v[132:135], v7, s[12:15], s29 offen sc1
    s_add_u32 s29, s28, 18432
    buffer_load_dwordx4 v[136:139], v7, s[12:15], s29 offen sc1
    s_add_u32 s29, s28, 19456
    buffer_load_dwordx4 v[140:143], v7, s[12:15], s29 offen sc1
    s_add_u32 s29, s28, 20480
    buffer_load_dwordx4 v[144:147], v7, s[12:15], s29 offen sc1
    s_add_u32 s29, s28, 21504
    buffer_load_dwordx4 v[148:151], v7, s[12:15], s29 offen sc1
    s_add_u32 s29, s28, 22528
    buffer_load_dwordx4 v[152:155], v7, s[12:15], s29 offen sc1
    s_add_u32 s29, s28, 23552
    buffer_load_dwordx4 v[156:159], v7, s[12:15], s29 offen sc1
    s_waitcnt lgkmcnt(8)
    v_mfma_f32_32x32x16_bf16 v[32:47], v[168:171], v[84:87], v[32:47]
    ds_read_b64_tr_b16 v[160:161], v10 offset:16384
    ds_read_b64_tr_b16 v[162:163], v10 offset:17408
    v_mfma_f32_32x32x16_bf16 v[48:63], v[172:175], v[84:87], v[48:63]
    ds_read_b64_tr_b16 v[164:165], v11 offset:16384
    ds_read_b64_tr_b16 v[166:167], v11 offset:17408
    s_waitcnt lgkmcnt(8)
    v_mfma_f32_32x32x16_bf16 v[32:47], v[176:179], v[88:91], v[32:47]
    ds_read_b64_tr_b16 v[168:169], v10 offset:18432
    ds_read_b64_tr_b16 v[170:171], v10 offset:19456
    v_mfma_f32_32x32x16_bf16 v[48:63], v[180:183], v[88:91], v[48:63]
    ds_read_b64_tr_b16 v[172:173], v11 offset:18432
    ds_read_b64_tr_b16 v[174:175], v11 offset:19456
    s_waitcnt vmcnt(24)
    v_cmp_eq_u32 vcc, 0, v1
    s_nop 0
    s_and_saveexec_b64 s[60:61], vcc
    buffer_atomic_add v12, v14, s[48:51], 0 offen
    s_mov_b64 exec, -1
    s_waitcnt lgkmcnt(8)
    v_mfma_f32_32x32x16_bf16 v[32:47], v[184:187], v[92:95], v[32:47]
    ds_read_b64_tr_b16 v[176:177], v10 offset:20480
    ds_read_b64_tr_b16 v[178:179], v10 offset:21504
    v_mfma_f32_32x32x16_bf16 v[48:63], v[188:191], v[92:95], v[48:63]
    ds_read_b64_tr_b16 v[180:181], v11 offset:20480
    ds_read_b64_tr_b16 v[182:183], v11 offset:21504
    s_waitcnt vmcnt(9)
    s_waitcnt lgkmcnt(8)
    v_mfma_f32_32x32x16_bf16 v[32:47], v[160:163], v[96:99], v[32:47]
    ds_read_b64_tr_b16 v[184:185], v10 offset:22528
    ds_read_b64_tr_b16 v[186:187], v10 offset:23552
    v_mfma_f32_32x32x16_bf16 v[48:63], v[164:167], v[96:99], v[48:63]
    ds_read_b64_tr_b16 v[188:189], v11 offset:22528
    ds_read_b64_tr_b16 v[190:191], v11 offset:23552
    s_waitcnt lgkmcnt(8)
    v_mfma_f32_32x32x16_bf16 v[32:47], v[168:171], v[100:103], v[32:47]
    ds_read_b64_tr_b16 v[160:161], v10 offset:24576
    ds_read_b64_tr_b16 v[162:163], v10 offset:25600
    v_mfma_f32_32x32x16_bf16 v[48:63], v[172:175], v[100:103], v[48:63]
    ds_read_b64_tr_b16 v[164:165], v11 offset:24576
    ds_read_b64_tr_b16 v[166:167], v11 offset:25600
    s_waitcnt lgkmcnt(8)
    v_mfma_f32_32x32x16_bf16 v[32:47], v[176:179], v[104:107], v[32:47]
    ds_read_b64_tr_b16 v[168:169], v10 offset:26624
    ds_read_b64_tr_b16 v[170:171], v10 offset:27648
    v_mfma_f32_32x32x16_bf16 v[48:63], v[180:183], v[104:107], v[48:63]
    ds_read_b64_tr_b16 v[172:173], v11 offset:26624
    ds_read_b64_tr_b16 v[174:175], v11 offset:27648
    s_waitcnt lgkmcnt(8)
    v_mfma_f32_32x32x16_bf16 v[32:47], v[184:187], v[108:111], v[32:47]
    ds_read_b64_tr_b16 v[176:177], v10 offset:28672
    ds_read_b64_tr_b16 v[178:179], v10 offset:29696
    v_mfma_f32_32x32x16_bf16 v[48:63], v[188:191], v[108:111], v[48:63]
    ds_read_b64_tr_b16 v[180:181], v11 offset:28672
    ds_read_b64_tr_b16 v[182:183], v11 offset:29696
    s_waitcnt lgkmcnt(8)
    v_mfma_f32_32x32x16_bf16 v[32:47], v[160:163], v[112:115], v[32:47]
    ds_read_b64_tr_b16 v[184:185], v10 offset:30720
    ds_read_b64_tr_b16 v[186:187], v10 offset:31744
    v_mfma_f32_32x32x16_bf16 v[48:63], v[164:167], v[112:115], v[48:63]
    ds_read_b64_tr_b16 v[188:189], v11 offset:30720
    ds_read_b64_tr_b16 v[190:191], v11 offset:31744
    s_add_u32 s29, s28, 24576
    buffer_load_dwordx4 v[64:67], v7, s[12:15], s29 offen sc1
    s_add_u32 s29, s28, 25600
    buffer_load_dwordx4 v[68:71], v7, s[12:15], s29 offen sc1
    s_add_u32 s29, s28, 26624
    buffer_load_dwordx4 v[72:75], v7, s[12:15], s29 offen sc1
    s_add_u32 s29, s28, 27648
    buffer_load_dwordx4 v[76:79], v7, s[12:15], s29 offen sc1
    s_add_u32 s29, s28, 28672
    buffer_load_dwordx4 v[80:83], v7, s[12:15], s29 offen sc1
    s_add_u32 s29, s28, 29696
    buffer_load_dwordx4 v[84:87], v7, s[12:15], s29 offen sc1
    s_add_u32 s29, s28, 30720
    buffer_load_dwordx4 v[88:91], v7, s[12:15], s29 offen sc1
    s_add_u32 s29, s28, 31744
    buffer_load_dwordx4 v[92:95], v7, s[12:15], s29 offen sc1
    s_waitcnt lgkmcnt(8)
    v_mfma_f32_32x32x16_bf16 v[32:47], v[168:171], v[116:119], v[32:47]
    ds_read_b64_tr_b16 v[160:161], v10 offset:32768
    ds_read_b64_tr_b16 v[162:163], v10 offset:33792
    v_mfma_f32_32x32x16_bf16 v[48:63], v[172:175], v[116:119], v[48:63]
    ds_read_b64_tr_b16 v[164:165], v11 offset:32768
    ds_read_b64_tr_b16 v[166:167], v11 offset:33792
    s_waitcnt lgkmcnt(8)
    v_mfma_f32_32x32x16_bf16 v[32:47], v[176:179], v[120:123], v[32:47]
    ds_read_b64_tr_b16 v[168:169], v10 offset:34816
    ds_read_b64_tr_b16 v[170:171], v10 offset:35840
    v_mfma_f32_32x32x16_bf16 v[48:63], v[180:183], v[120:123], v[48:63]
    ds_read_b64_tr_b16 v[172:173], v11 offset:34816
    ds_read_b64_tr_b16 v[174:175], v11 offset:35840
    s_waitcnt lgkmcnt(8)
    v_mfma_f32_32x32x16_bf16 v[32:47], v[184:187], v[124:127], v[32:47]
    ds_read_b64_tr_b16 v[176:177], v10 offset:36864
    ds_read_b64_tr_b16 v[178:179], v10 offset:37888
    v_mfma_f32_32x32x16_bf16 v[48:63], v[188:191], v[124:127], v[48:63]
    ds_read_b64_tr_b16 v[180:181], v11 offset:36864
    ds_read_b64_tr_b16 v[182:183], v11 offset:37888
    s_waitcnt vmcnt(9)
    s_waitcnt lgkmcnt(8)
    v_mfma_f32_32x32x16_bf16 v[32:47], v[160:163], v[128:131], v[32:47]
    ds_read_b64_tr_b16 v[184:185], v10 offset:38912
    ds_read_b64_tr_b16 v[186:187], v10 offset:39936
    v_mfma_f32_32x32x16_bf16 v[48:63], v[164:167], v[128:131], v[48:63]
    ds_read_b64_tr_b16 v[188:189], v11 offset:38912
    ds_read_b64_tr_b16 v[190:191], v11 offset:39936
    s_waitcnt lgkmcnt(8)
    v_mfma_f32_32x32x16_bf16 v[32:47], v[168:171], v[132:135], v[32:47]
    ds_read_b64_tr_b16 v[160:161], v10 offset:40960
    ds_read_b64_tr_b16 v[162:163], v10 offset:41984
    v_mfma_f32_32x32x16_bf16 v[48:63], v[172:175], v[132:135], v[48:63]
    ds_read_b64_tr_b16 v[164:165], v11 offset:40960
    ds_read_b64_tr_b16 v[166:167], v11 offset:41984
    s_waitcnt lgkmcnt(8)
    v_mfma_f32_32x32x16_bf16 v[32:47], v[176:179], v[136:139], v[32:47]
    ds_read_b64_tr_b16 v[168:169], v10 offset:43008
    ds_read_b64_tr_b16 v[170:171], v10 offset:44032
    v_mfma_f32_32x32x16_bf16 v[48:63], v[180:183], v[136:139], v[48:63]
    ds_read_b64_tr_b16 v[172:173], v11 offset:43008
    ds_read_b64_tr_b16 v[174:175], v11 offset:44032
    s_waitcnt lgkmcnt(8)
    v_mfma_f32_32x32x16_bf16 v[32:47], v[184:187], v[140:143], v[32:47]
    ds_read_b64_tr_b16 v[176:177], v10 offset:45056
    ds_read_b64_tr_b16 v[178:179], v10 offset:46080
    v_mfma_f32_32x32x16_bf16 v[48:63], v[188:191], v[140:143], v[48:63]
    ds_read_b64_tr_b16 v[180:181], v11 offset:45056
    ds_read_b64_tr_b16 v[182:183], v11 offset:46080
    s_waitcnt lgkmcnt(8)
    v_mfma_f32_32x32x16_bf16 v[32:47], v[160:163], v[144:147], v[32:47]
    ds_read_b64_tr_b16 v[184:185], v10 offset:47104
    ds_read_b64_tr_b16 v[186:187], v10 offset:48128
    v_mfma_f32_32x32x16_bf16 v[48:63], v[164:167], v[144:147], v[48:63]
    ds_read_b64_tr_b16 v[188:189], v11 offset:47104
    ds_read_b64_tr_b16 v[190:191], v11 offset:48128
    s_add_u32 s29, s28, 32768
    buffer_load_dwordx4 v[96:99], v7, s[12:15], s29 offen sc1
    s_add_u32 s29, s28, 33792
    buffer_load_dwordx4 v[100:103], v7, s[12:15], s29 offen sc1
    s_add_u32 s29, s28, 34816
    buffer_load_dwordx4 v[104:107], v7, s[12:15], s29 offen sc1
    s_add_u32 s29, s28, 35840
    buffer_load_dwordx4 v[108:111], v7, s[12:15], s29 offen sc1
    s_add_u32 s29, s28, 36864
    buffer_load_dwordx4 v[112:115], v7, s[12:15], s29 offen sc1
    s_add_u32 s29, s28, 37888
    buffer_load_dwordx4 v[116:119], v7, s[12:15], s29 offen sc1
    s_add_u32 s29, s28, 38912
    buffer_load_dwordx4 v[120:123], v7, s[12:15], s29 offen sc1
    s_add_u32 s29, s28, 39936
    buffer_load_dwordx4 v[124:127], v7, s[12:15], s29 offen sc1
    s_waitcnt lgkmcnt(8)
    v_mfma_f32_32x32x16_bf16 v[32:47], v[168:171], v[148:151], v[32:47]
    ds_read_b64_tr_b16 v[160:161], v10 offset:49152
    ds_read_b64_tr_b16 v[162:163], v10 offset:50176
    v_mfma_f32_32x32x16_bf16 v[48:63], v[172:175], v[148:151], v[48:63]
    ds_read_b64_tr_b16 v[164:165], v11 offset:49152
    ds_read_b64_tr_b16 v[166:167], v11 offset:50176
    s_waitcnt lgkmcnt(8)
    v_mfma_f32_32x32x16_bf16 v[32:47], v[176:179], v[152:155], v[32:47]
    ds_read_b64_tr_b16 v[168:169], v10 offset:51200
    ds_read_b64_tr_b16 v[170:171], v10 offset:52224
    v_mfma_f32_32x32x16_bf16 v[48:63], v[180:183], v[152:155], v[48:63]
    ds_read_b64_tr_b16 v[172:173], v11 offset:51200
    ds_read_b64_tr_b16 v[174:175], v11 offset:52224
    s_waitcnt lgkmcnt(8)
    v_mfma_f32_32x32x16_bf16 v[32:47], v[184:187], v[156:159], v[32:47]
    ds_read_b64_tr_b16 v[176:177], v10 offset:53248
    ds_read_b64_tr_b16 v[178:179], v10 offset:54272
    v_mfma_f32_32x32x16_bf16 v[48:63], v[188:191], v[156:159], v[48:63]
    ds_read_b64_tr_b16 v[180:181], v11 offset:53248
    ds_read_b64_tr_b16 v[182:183], v11 offset:54272
    s_waitcnt vmcnt(8)
    s_waitcnt lgkmcnt(8)
    v_mfma_f32_32x32x16_bf16 v[32:47], v[160:163], v[64:67], v[32:47]
    ds_read_b64_tr_b16 v[184:185], v10 offset:55296
    ds_read_b64_tr_b16 v[186:187], v10 offset:56320
    v_mfma_f32_32x32x16_bf16 v[48:63], v[164:167], v[64:67], v[48:63]
    ds_read_b64_tr_b16 v[188:189], v11 offset:55296
    ds_read_b64_tr_b16 v[190:191], v11 offset:56320
    s_waitcnt lgkmcnt(8)
    v_mfma_f32_32x32x16_bf16 v[32:47], v[168:171], v[68:71], v[32:47]
    ds_read_b64_tr_b16 v[160:161], v10 offset:57344
    ds_read_b64_tr_b16 v[162:163], v10 offset:58368
    v_mfma_f32_32x32x16_bf16 v[48:63], v[172:175], v[68:71], v[48:63]
    ds_read_b64_tr_b16 v[164:165], v11 offset:57344
    ds_read_b64_tr_b16 v[166:167], v11 offset:58368
    s_waitcnt lgkmcnt(8)
    v_mfma_f32_32x32x16_bf16 v[32:47], v[176:179], v[72:75], v[32:47]
    ds_read_b64_tr_b16 v[168:169], v10 offset:59392
    ds_read_b64_tr_b16 v[170:171], v10 offset:60416
    v_mfma_f32_32x32x16_bf16 v[48:63], v[180:183], v[72:75], v[48:63]
    ds_read_b64_tr_b16 v[172:173], v11 offset:59392
    ds_read_b64_tr_b16 v[174:175], v11 offset:60416
    s_cmp_lg_u32 s22, 0
    s_cbranch_scc1 L_k23_y_ok
L_k23_poll_y:
    buffer_load_dword v2, v14, s[48:51], 0 offen sc1
    s_waitcnt vmcnt(0)
    v_readfirstlane_b32 s3, v2
    s_nop 1
    s_cmp_ge_u32 s3, 128
    s_cbranch_scc1 L_k23_y_ok
    s_sleep 8
    s_branch L_k23_poll_y
L_k23_y_ok:
    s_waitcnt lgkmcnt(8)
    v_mfma_f32_32x32x16_bf16 v[32:47], v[184:187], v[76:79], v[32:47]
    ds_read_b64_tr_b16 v[176:177], v10 offset:61440
    ds_read_b64_tr_b16 v[178:179], v10 offset:62464
    v_mfma_f32_32x32x16_bf16 v[48:63], v[188:191], v[76:79], v[48:63]
    ds_read_b64_tr_b16 v[180:181], v11 offset:61440
    ds_read_b64_tr_b16 v[182:183], v11 offset:62464
    s_barrier
    s_waitcnt lgkmcnt(8)
    v_mfma_f32_32x32x16_bf16 v[32:47], v[160:163], v[80:83], v[32:47]
    ds_read_b64_tr_b16 v[184:185], v10 offset:63488
    ds_read_b64_tr_b16 v[186:187], v10 offset:64512
    v_mfma_f32_32x32x16_bf16 v[48:63], v[164:167], v[80:83], v[48:63]
    ds_read_b64_tr_b16 v[188:189], v11 offset:63488
    ds_read_b64_tr_b16 v[190:191], v11 offset:64512
    s_add_u32 s26, s25, 0
    buffer_load_dwordx4 v[16:19], v3, s[12:15], s26 offen sc1
    s_add_u32 s26, s25, 131072
    buffer_load_dwordx4 v[20:23], v3, s[12:15], s26 offen sc1
    s_add_u32 s26, s25, 262144
    buffer_load_dwordx4 v[24:27], v3, s[12:15], s26 offen sc1
    s_add_u32 s26, s25, 393216
    buffer_load_dwordx4 v[28:31], v3, s[12:15], s26 offen sc1
    s_add_u32 s29, s28, 40960
    buffer_load_dwordx4 v[128:131], v7, s[12:15], s29 offen sc1
    s_add_u32 s29, s28, 41984
    buffer_load_dwordx4 v[132:135], v7, s[12:15], s29 offen sc1
    s_add_u32 s29, s28, 43008
    buffer_load_dwordx4 v[136:139], v7, s[12:15], s29 offen sc1
    s_add_u32 s29, s28, 44032
    buffer_load_dwordx4 v[140:143], v7, s[12:15], s29 offen sc1
    s_add_u32 s29, s28, 45056
    buffer_load_dwordx4 v[144:147], v7, s[12:15], s29 offen sc1
    s_add_u32 s29, s28, 46080
    buffer_load_dwordx4 v[148:151], v7, s[12:15], s29 offen sc1
    s_add_u32 s29, s28, 47104
    buffer_load_dwordx4 v[152:155], v7, s[12:15], s29 offen sc1
    s_add_u32 s29, s28, 48128
    buffer_load_dwordx4 v[156:159], v7, s[12:15], s29 offen sc1
    s_waitcnt lgkmcnt(8)
    v_mfma_f32_32x32x16_bf16 v[32:47], v[168:171], v[84:87], v[32:47]
    ds_read_b64_tr_b16 v[160:161], v6 offset:0
    ds_read_b64_tr_b16 v[162:163], v6 offset:1024
    v_mfma_f32_32x32x16_bf16 v[48:63], v[172:175], v[84:87], v[48:63]
    ds_read_b64_tr_b16 v[164:165], v13 offset:0
    ds_read_b64_tr_b16 v[166:167], v13 offset:1024
    s_waitcnt lgkmcnt(8)
    v_mfma_f32_32x32x16_bf16 v[32:47], v[176:179], v[88:91], v[32:47]
    ds_read_b64_tr_b16 v[168:169], v6 offset:2048
    ds_read_b64_tr_b16 v[170:171], v6 offset:3072
    v_mfma_f32_32x32x16_bf16 v[48:63], v[180:183], v[88:91], v[48:63]
    ds_read_b64_tr_b16 v[172:173], v13 offset:2048
    ds_read_b64_tr_b16 v[174:175], v13 offset:3072
    s_waitcnt lgkmcnt(8)
    v_mfma_f32_32x32x16_bf16 v[32:47], v[184:187], v[92:95], v[32:47]
    ds_read_b64_tr_b16 v[176:177], v6 offset:4096
    ds_read_b64_tr_b16 v[178:179], v6 offset:5120
    v_mfma_f32_32x32x16_bf16 v[48:63], v[188:191], v[92:95], v[48:63]
    ds_read_b64_tr_b16 v[180:181], v13 offset:4096
    ds_read_b64_tr_b16 v[182:183], v13 offset:5120
    s_waitcnt vmcnt(12)
    s_waitcnt lgkmcnt(8)
    v_mfma_f32_32x32x16_bf16 v[32:47], v[160:163], v[96:99], v[32:47]
    ds_read_b64_tr_b16 v[184:185], v6 offset:6144
    ds_read_b64_tr_b16 v[186:187], v6 offset:7168
    v_mfma_f32_32x32x16_bf16 v[48:63], v[164:167], v[96:99], v[48:63]
    ds_read_b64_tr_b16 v[188:189], v13 offset:6144
    ds_read_b64_tr_b16 v[190:191], v13 offset:7168
    s_waitcnt lgkmcnt(8)
    v_mfma_f32_32x32x16_bf16 v[32:47], v[168:171], v[100:103], v[32:47]
    ds_read_b64_tr_b16 v[160:161], v6 offset:8192
    ds_read_b64_tr_b16 v[162:163], v6 offset:9216
    v_mfma_f32_32x32x16_bf16 v[48:63], v[172:175], v[100:103], v[48:63]
    ds_read_b64_tr_b16 v[164:165], v13 offset:8192
    ds_read_b64_tr_b16 v[166:167], v13 offset:9216
    s_waitcnt lgkmcnt(8)
    v_mfma_f32_32x32x16_bf16 v[32:47], v[176:179], v[104:107], v[32:47]
    ds_read_b64_tr_b16 v[168:169], v6 offset:10240
    ds_read_b64_tr_b16 v[170:171], v6 offset:11264
    v_mfma_f32_32x32x16_bf16 v[48:63], v[180:183], v[104:107], v[48:63]
    ds_read_b64_tr_b16 v[172:173], v13 offset:10240
    ds_read_b64_tr_b16 v[174:175], v13 offset:11264
    s_waitcnt lgkmcnt(8)
    v_mfma_f32_32x32x16_bf16 v[32:47], v[184:187], v[108:111], v[32:47]
    ds_read_b64_tr_b16 v[176:177], v6 offset:12288
    ds_read_b64_tr_b16 v[178:179], v6 offset:13312
    v_mfma_f32_32x32x16_bf16 v[48:63], v[188:191], v[108:111], v[48:63]
    ds_read_b64_tr_b16 v[180:181], v13 offset:12288
    ds_read_b64_tr_b16 v[182:183], v13 offset:13312
    s_waitcnt lgkmcnt(8)
    v_mfma_f32_32x32x16_bf16 v[32:47], v[160:163], v[112:115], v[32:47]
    ds_read_b64_tr_b16 v[184:185], v6 offset:14336
    ds_read_b64_tr_b16 v[186:187], v6 offset:15360
    v_mfma_f32_32x32x16_bf16 v[48:63], v[164:167], v[112:115], v[48:63]
    ds_read_b64_tr_b16 v[188:189], v13 offset:14336
    ds_read_b64_tr_b16 v[190:191], v13 offset:15360
    s_add_u32 s29, s28, 49152
    buffer_load_dwordx4 v[64:67], v7, s[12:15], s29 offen sc1
    s_add_u32 s29, s28, 50176
    buffer_load_dwordx4 v[68:71], v7, s[12:15], s29 offen sc1
    s_add_u32 s29, s28, 51200
    buffer_load_dwordx4 v[72:75], v7, s[12:15], s29 offen sc1
    s_add_u32 s29, s28, 52224
    buffer_load_dwordx4 v[76:79], v7, s[12:15], s29 offen sc1
    s_add_u32 s29, s28, 53248
    buffer_load_dwordx4 v[80:83], v7, s[12:15], s29 offen sc1
    s_add_u32 s29, s28, 54272
    buffer_load_dwordx4 v[84:87], v7, s[12:15], s29 offen sc1
    s_add_u32 s29, s28, 55296
    buffer_load_dwordx4 v[88:91], v7, s[12:15], s29 offen sc1
    s_add_u32 s29, s28, 56320
    buffer_load_dwordx4 v[92:95], v7, s[12:15], s29 offen sc1
    s_waitcnt lgkmcnt(8)
    v_mfma_f32_32x32x16_bf16 v[32:47], v[168:171], v[116:119], v[32:47]
    ds_read_b64_tr_b16 v[160:161], v6 offset:21824
    ds_read_b64_tr_b16 v[162:163], v6 offset:22848
    v_mfma_f32_32x32x16_bf16 v[48:63], v[172:175], v[116:119], v[48:63]
    ds_read_b64_tr_b16 v[164:165], v13 offset:21824
    ds_read_b64_tr_b16 v[166:167], v13 offset:22848
    s_waitcnt lgkmcnt(8)
    v_mfma_f32_32x32x16_bf16 v[32:47], v[176:179], v[120:123], v[32:47]
    ds_read_b64_tr_b16 v[168:169], v6 offset:23872
    ds_read_b64_tr_b16 v[170:171], v6 offset:24896
    v_mfma_f32_32x32x16_bf16 v[48:63], v[180:183], v[120:123], v[48:63]
    ds_read_b64_tr_b16 v[172:173], v13 offset:23872
    ds_read_b64_tr_b16 v[174:175], v13 offset:24896
    s_waitcnt lgkmcnt(8)
    v_mfma_f32_32x32x16_bf16 v[32:47], v[184:187], v[124:127], v[32:47]
    ds_read_b64_tr_b16 v[176:177], v6 offset:25920
    ds_read_b64_tr_b16 v[178:179], v6 offset:26944
    v_mfma_f32_32x32x16_bf16 v[48:63], v[188:191], v[124:127], v[48:63]
    ds_read_b64_tr_b16 v[180:181], v13 offset:25920
    ds_read_b64_tr_b16 v[182:183], v13 offset:26944
    s_waitcnt vmcnt(8)
    s_waitcnt lgkmcnt(8)
    v_mfma_f32_32x32x16_bf16 v[32:47], v[160:163], v[128:131], v[32:47]
    ds_read_b64_tr_b16 v[184:185], v6 offset:27968
    ds_read_b64_tr_b16 v[186:187], v6 offset:28992
    v_mfma_f32_32x32x16_bf16 v[48:63], v[164:167], v[128:131], v[48:63]
    ds_read_b64_tr_b16 v[188:189], v13 offset:27968
    ds_read_b64_tr_b16 v[190:191], v13 offset:28992
    ds_write_b128 v15, v[16:19] offset:0
    ds_write_b128 v15, v[20:23] offset:4608
    ds_write_b128 v15, v[24:27] offset:9216
    ds_write_b128 v15, v[28:31] offset:13824
    s_waitcnt lgkmcnt(8)
    v_mfma_f32_32x32x16_bf16 v[32:47], v[168:171], v[132:135], v[32:47]
    ds_read_b64_tr_b16 v[160:161], v6 offset:30016
    ds_read_b64_tr_b16 v[162:163], v6 offset:31040
    v_mfma_f32_32x32x16_bf16 v[48:63], v[172:175], v[132:135], v[48:63]
    ds_read_b64_tr_b16 v[164:165], v13 offset:30016
    ds_read_b64_tr_b16 v[166:167], v13 offset:31040
    s_waitcnt lgkmcnt(8)
    v_mfma_f32_32x32x16_bf16 v[32:47], v[176:179], v[136:139], v[32:47]
    ds_read_b64_tr_b16 v[168:169], v6 offset:32064
    ds_read_b64_tr_b16 v[170:171], v6 offset:33088
    v_mfma_f32_32x32x16_bf16 v[48:63], v[180:183], v[136:139], v[48:63]
    ds_read_b64_tr_b16 v[172:173], v13 offset:32064
    ds_read_b64_tr_b16 v[174:175], v13 offset:33088
    s_waitcnt lgkmcnt(8)
    v_mfma_f32_32x32x16_bf16 v[32:47], v[184:187], v[140:143], v[32:47]
    ds_read_b64_tr_b16 v[176:177], v6 offset:34112
    ds_read_b64_tr_b16 v[178:179], v6 offset:35136
    v_mfma_f32_32x32x16_bf16 v[48:63], v[188:191], v[140:143], v[48:63]
    ds_read_b64_tr_b16 v[180:181], v13 offset:34112
    ds_read_b64_tr_b16 v[182:183], v13 offset:35136
    s_barrier
    s_waitcnt lgkmcnt(8)
    v_mfma_f32_32x32x16_bf16 v[32:47], v[160:163], v[144:147], v[32:47]
    ds_read_b64_tr_b16 v[184:185], v6 offset:36160
    ds_read_b64_tr_b16 v[186:187], v6 offset:37184
    v_mfma_f32_32x32x16_bf16 v[48:63], v[164:167], v[144:147], v[48:63]
    ds_read_b64_tr_b16 v[188:189], v13 offset:36160
    ds_read_b64_tr_b16 v[190:191], v13 offset:37184
    s_add_u32 s29, s28, 57344
    buffer_load_dwordx4 v[96:99], v7, s[12:15], s29 offen sc1
    s_add_u32 s29, s28, 58368
    buffer_load_dwordx4 v[100:103], v7, s[12:15], s29 offen sc1
    s_add_u32 s29, s28, 59392
    buffer_load_dwordx4 v[104:107], v7, s[12:15], s29 offen sc1
    s_add_u32 s29, s28, 60416
    buffer_load_dwordx4 v[108:111], v7, s[12:15], s29 offen sc1
    s_add_u32 s29, s28, 61440
    buffer_load_dwordx4 v[112:115], v7, s[12:15], s29 offen sc1
    s_add_u32 s29, s28, 62464
    buffer_load_dwordx4 v[116:119], v7, s[12:15], s29 offen sc1
    s_add_u32 s29, s28, 63488
    buffer_load_dwordx4 v[120:123], v7, s[12:15], s29 offen sc1
    s_add_u32 s29, s28, 64512
    buffer_load_dwordx4 v[124:127], v7, s[12:15], s29 offen sc1
    s_waitcnt lgkmcnt(8)
    v_mfma_f32_32x32x16_bf16 v[32:47], v[168:171], v[148:151], v[32:47]
    ds_read_b64_tr_b16 v[160:161], v6 offset:43648
    ds_read_b64_tr_b16 v[162:163], v6 offset:44672
    v_mfma_f32_32x32x16_bf16 v[48:63], v[172:175], v[148:151], v[48:63]
    ds_read_b64_tr_b16 v[164:165], v13 offset:43648
    ds_read_b64_tr_b16 v[166:167], v13 offset:44672
    ds_read_b64_tr_b16 v[16:17], v8 offset:0
    ds_read_b64_tr_b16 v[18:19], v8 offset:576
    ds_read_b64_tr_b16 v[20:21], v8 offset:32
    ds_read_b64_tr_b16 v[22:23], v8 offset:608
    ds_read_b64_tr_b16 v[24:25], v8 offset:64
    ds_read_b64_tr_b16 v[26:27], v8 offset:640
    ds_read_b64_tr_b16 v[28:29], v8 offset:96
    ds_read_b64_tr_b16 v[30:31], v8 offset:672
    s_waitcnt lgkmcnt(8)
    v_mfma_f32_32x32x16_bf16 v[32:47], v[176:179], v[152:155], v[32:47]
    ds_read_b64_tr_b16 v[168:169], v6 offset:45696
    ds_read_b64_tr_b16 v[170:171], v6 offset:46720
    v_mfma_f32_32x32x16_bf16 v[48:63], v[180:183], v[152:155], v[48:63]
    ds_read_b64_tr_b16 v[172:173], v13 offset:45696
    ds_read_b64_tr_b16 v[174:175], v13 offset:46720
    s_waitcnt lgkmcnt(8)
    v_mfma_f32_32x32x16_bf16 v[32:47], v[184:187], v[156:159], v[32:47]
    ds_read_b64_tr_b16 v[176:177], v6 offset:47744
    ds_read_b64_tr_b16 v[178:179], v6 offset:48768
    v_mfma_f32_32x32x16_bf16 v[48:63], v[188:191], v[156:159], v[48:63]
    ds_read_b64_tr_b16 v[180:181], v13 offset:47744
    ds_read_b64_tr_b16 v[182:183], v13 offset:48768
    s_waitcnt vmcnt(8)
    s_waitcnt lgkmcnt(8)
    v_mfma_f32_32x32x16_bf16 v[32:47], v[160:163], v[64:67], v[32:47]
    ds_read_b64_tr_b16 v[184:185], v6 offset:49792
    ds_read_b64_tr_b16 v[186:187], v6 offset:50816
    v_mfma_f32_32x32x16_bf16 v[48:63], v[164:167], v[64:67], v[48:63]
    ds_read_b64_tr_b16 v[188:189], v13 offset:49792
    ds_read_b64_tr_b16 v[190:191], v13 offset:50816
    s_waitcnt lgkmcnt(8)
    v_mfma_f32_32x32x16_bf16 v[32:47], v[168:171], v[68:71], v[32:47]
    ds_read_b64_tr_b16 v[160:161], v6 offset:51840
    ds_read_b64_tr_b16 v[162:163], v6 offset:52864
    v_mfma_f32_32x32x16_bf16 v[48:63], v[172:175], v[68:71], v[48:63]
    ds_read_b64_tr_b16 v[164:165], v13 offset:51840
    ds_read_b64_tr_b16 v[166:167], v13 offset:52864
    s_add_u32 s29, s30, 0
    buffer_store_dwordx4 v[16:19], v9, s[56:59], s29 offen
    s_add_u32 s29, s30, 65536
    buffer_store_dwordx4 v[20:23], v9, s[56:59], s29 offen
    s_add_u32 s29, s30, 131072
    buffer_store_dwordx4 v[24:27], v9, s[56:59], s29 offen
    s_add_u32 s29, s30, 196608
    buffer_store_dwordx4 v[28:31], v9, s[56:59], s29 offen
    s_waitcnt lgkmcnt(8)
    v_mfma_f32_32x32x16_bf16 v[32:47], v[176:179], v[72:75], v[32:47]
    ds_read_b64_tr_b16 v[168:169], v6 offset:53888
    ds_read_b64_tr_b16 v[170:171], v6 offset:54912
    v_mfma_f32_32x32x16_bf16 v[48:63], v[180:183], v[72:75], v[48:63]
    ds_read_b64_tr_b16 v[172:173], v13 offset:53888
    ds_read_b64_tr_b16 v[174:175], v13 offset:54912
    s_waitcnt lgkmcnt(8)
    v_mfma_f32_32x32x16_bf16 v[32:47], v[184:187], v[76:79], v[32:47]
    ds_read_b64_tr_b16 v[176:177], v6 offset:55936
    ds_read_b64_tr_b16 v[178:179], v6 offset:56960
    v_mfma_f32_32x32x16_bf16 v[48:63], v[188:191], v[76:79], v[48:63]
    ds_read_b64_tr_b16 v[180:181], v13 offset:55936
    ds_read_b64_tr_b16 v[182:183], v13 offset:56960
    s_waitcnt lgkmcnt(8)
    v_mfma_f32_32x32x16_bf16 v[32:47], v[160:163], v[80:83], v[32:47]
    ds_read_b64_tr_b16 v[184:185], v6 offset:57984
    ds_read_b64_tr_b16 v[186:187], v6 offset:59008
    v_mfma_f32_32x32x16_bf16 v[48:63], v[164:167], v[80:83], v[48:63]
    ds_read_b64_tr_b16 v[188:189], v13 offset:57984
    ds_read_b64_tr_b16 v[190:191], v13 offset:59008
    s_waitcnt lgkmcnt(8)
    v_mfma_f32_32x32x16_bf16 v[32:47], v[168:171], v[84:87], v[32:47]
    ds_read_b64_tr_b16 v[160:161], v4 offset:0
    ds_read_b64_tr_b16 v[162:163], v4 offset:1024
    v_mfma_f32_32x32x16_bf16 v[48:63], v[172:175], v[84:87], v[48:63]
    ds_read_b64_tr_b16 v[164:165], v5 offset:0
    ds_read_b64_tr_b16 v[166:167], v5 offset:1024
    s_waitcnt lgkmcnt(8)
    v_mfma_f32_32x32x16_bf16 v[32:47], v[176:179], v[88:91], v[32:47]
    ds_read_b64_tr_b16 v[168:169], v4 offset:2048
    ds_read_b64_tr_b16 v[170:171], v4 offset:3072
    v_mfma_f32_32x32x16_bf16 v[48:63], v[180:183], v[88:91], v[48:63]
    ds_read_b64_tr_b16 v[172:173], v5 offset:2048
    ds_read_b64_tr_b16 v[174:175], v5 offset:3072
    s_waitcnt lgkmcnt(8)
    v_mfma_f32_32x32x16_bf16 v[32:47], v[184:187], v[92:95], v[32:47]
    ds_read_b64_tr_b16 v[176:177], v4 offset:4096
    ds_read_b64_tr_b16 v[178:179], v4 offset:5120
    v_mfma_f32_32x32x16_bf16 v[48:63], v[188:191], v[92:95], v[48:63]
    ds_read_b64_tr_b16 v[180:181], v5 offset:4096
    ds_read_b64_tr_b16 v[182:183], v5 offset:5120
    s_waitcnt vmcnt(4)
    s_waitcnt lgkmcnt(8)
    v_mfma_f32_32x32x16_bf16 v[32:47], v[160:163], v[96:99], v[32:47]
    ds_read_b64_tr_b16 v[184:185], v4 offset:6144
    ds_read_b64_tr_b16 v[186:187], v4 offset:7168
    v_mfma_f32_32x32x16_bf16 v[48:63], v[164:167], v[96:99], v[48:63]
    ds_read_b64_tr_b16 v[188:189], v5 offset:6144
    ds_read_b64_tr_b16 v[190:191], v5 offset:7168
    s_waitcnt lgkmcnt(8)
    v_mfma_f32_32x32x16_bf16 v[32:47], v[168:171], v[100:103], v[32:47]
    ds_read_b64_tr_b16 v[160:161], v4 offset:8192
    ds_read_b64_tr_b16 v[162:163], v4 offset:9216
    v_mfma_f32_32x32x16_bf16 v[48:63], v[172:175], v[100:103], v[48:63]
    ds_read_b64_tr_b16 v[164:165], v5 offset:8192
    ds_read_b64_tr_b16 v[166:167], v5 offset:9216
    s_waitcnt lgkmcnt(8)
    v_mfma_f32_32x32x16_bf16 v[32:47], v[176:179], v[104:107], v[32:47]
    ds_read_b64_tr_b16 v[168:169], v4 offset:10240
    ds_read_b64_tr_b16 v[170:171], v4 offset:11264
    v_mfma_f32_32x32x16_bf16 v[48:63], v[180:183], v[104:107], v[48:63]
    ds_read_b64_tr_b16 v[172:173], v5 offset:10240
    ds_read_b64_tr_b16 v[174:175], v5 offset:11264
    s_waitcnt lgkmcnt(8)
    v_mfma_f32_32x32x16_bf16 v[32:47], v[184:187], v[108:111], v[32:47]
    ds_read_b64_tr_b16 v[176:177], v4 offset:12288
    ds_read_b64_tr_b16 v[178:179], v4 offset:13312
    v_mfma_f32_32x32x16_bf16 v[48:63], v[188:191], v[108:111], v[48:63]
    ds_read_b64_tr_b16 v[180:181], v5 offset:12288
    ds_read_b64_tr_b16 v[182:183], v5 offset:13312
    s_waitcnt lgkmcnt(8)
    v_mfma_f32_32x32x16_bf16 v[32:47], v[160:163], v[112:115], v[32:47]
    ds_read_b64_tr_b16 v[184:185], v4 offset:14336
    ds_read_b64_tr_b16 v[186:187], v4 offset:15360
    v_mfma_f32_32x32x16_bf16 v[48:63], v[164:167], v[112:115], v[48:63]
    ds_read_b64_tr_b16 v[188:189], v5 offset:14336
    ds_read_b64_tr_b16 v[190:191], v5 offset:15360
    s_waitcnt lgkmcnt(8)
    v_mfma_f32_32x32x16_bf16 v[32:47], v[168:171], v[116:119], v[32:47]
    v_mfma_f32_32x32x16_bf16 v[48:63], v[172:175], v[116:119], v[48:63]
    s_waitcnt lgkmcnt(4)
    v_mfma_f32_32x32x16_bf16 v[32:47], v[176:179], v[120:123], v[32:47]
    v_mfma_f32_32x32x16_bf16 v[48:63], v[180:183], v[120:123], v[48:63]
    s_waitcnt lgkmcnt(0)
    v_mfma_f32_32x32x16_bf16 v[32:47], v[184:187], v[124:127], v[32:47]
    v_mfma_f32_32x32x16_bf16 v[48:63], v[188:191], v[124:127], v[48:63]
    v_and_b32 v2, 31, v1
    s_lshl_b32 s26, s18, 7
    s_lshl_b32 s29, s22, 5
    s_add_u32 s26, s26, s29
    v_add_u32 v2, s26, v2
    v_lshlrev_b32 v2, 12, v2
    v_lshrrev_b32 v3, 5, v1
    v_lshlrev_b32 v3, 3, v3
    v_add_u32 v2, v2, v3
    s_lshl_b32 s26, s19, 7
    s_nop 0
    v_cvt_pk_bf16_f32 v64, v32, v33
    v_cvt_pk_bf16_f32 v65, v34, v35
    v_cvt_pk_bf16_f32 v66, v36, v37
    v_cvt_pk_bf16_f32 v67, v38, v39
    v_cvt_pk_bf16_f32 v68, v40, v41
    v_cvt_pk_bf16_f32 v69, v42, v43
    v_cvt_pk_bf16_f32 v70, v44, v45
    v_cvt_pk_bf16_f32 v71, v46, v47
    v_cvt_pk_bf16_f32 v72, v48, v49
    v_cvt_pk_bf16_f32 v73, v50, v51
    v_cvt_pk_bf16_f32 v74, v52, v53
    v_cvt_pk_bf16_f32 v75, v54, v55
    v_cvt_pk_bf16_f32 v76, v56, v57
    v_cvt_pk_bf16_f32 v77, v58, v59
    v_cvt_pk_bf16_f32 v78, v60, v61
    v_cvt_pk_bf16_f32 v79, v62, v63
    buffer_store_dwordx2 v[64:65], v2, s[56:59], s26 offen offset:0
    buffer_store_dwordx2 v[66:67], v2, s[56:59], s26 offen offset:16
    buffer_store_dwordx2 v[68:69], v2, s[56:59], s26 offen offset:32
    buffer_store_dwordx2 v[70:71], v2, s[56:59], s26 offen offset:48
    buffer_store_dwordx2 v[72:73], v2, s[56:59], s26 offen offset:64
    buffer_store_dwordx2 v[74:75], v2, s[56:59], s26 offen offset:80
    buffer_store_dwordx2 v[76:77], v2, s[56:59], s26 offen offset:96
    buffer_store_dwordx2 v[78:79], v2, s[56:59], s26 offen offset:112
    s_endpgm
L_k2_end:
    s_endpgm

.section .rodata,"a"
.p2align 6
.amdhsa_kernel k1_kernel
  .amdhsa_next_free_vgpr 224
  .amdhsa_next_free_sgpr 96
  .amdhsa_accum_offset 224
  .amdhsa_group_segment_fixed_size 0
  .amdhsa_kernarg_size 104
  .amdhsa_user_sgpr_count 2
  .amdhsa_user_sgpr_kernarg_segment_ptr 1
  .amdhsa_system_sgpr_workgroup_id_x 1
.end_amdhsa_kernel

.section .rodata,"a"
.p2align 6
.amdhsa_kernel k2_kernel
  .amdhsa_next_free_vgpr 192
  .amdhsa_next_free_sgpr 96
  .amdhsa_accum_offset 192
  .amdhsa_group_segment_fixed_size 0
  .amdhsa_kernarg_size 104
  .amdhsa_user_sgpr_count 2
  .amdhsa_user_sgpr_kernarg_segment_ptr 1
  .amdhsa_system_sgpr_workgroup_id_x 1
.end_amdhsa_kernel
```
